```python
import torch

def _softmax(x, axis=-1):
    return torch.softmax(x, dim=axis)

def _gelu(x):
    return torch.nn.functional.gelu(x, approximate='tanh')

def _silu(x):
    return torch.nn.functional.silu(x)

def _sigmoid(x):
    return torch.sigmoid(x)

def _layernorm(x, axis=-1, eps=1e-05):
    m = x.mean(dim=axis, keepdim=True)
    v = x.var(dim=axis, keepdim=True, unbiased=False)
    return (x - m) / torch.sqrt(v + eps)

def _scatter_add(tgt, idx, src, axis=0):
    return tgt.clone().index_add_(axis, idx, src)

def _segment_sum(src, seg, n):
    out = torch.zeros((n,) + src.shape[1:], dtype=src.dtype)
    return out.index_add_(0, seg, src)

def _pad(x, pw):
    flat = tuple((v for pair in reversed(pw) for v in pair))
    return torch.nn.functional.pad(x, flat)
kernel_name = 'standalone__swin_window_attn__vision'

def setup_inputs():

    _w = lambda a: (lambda t: t.to(torch.bfloat16) if t.is_floating_point() else t)(torch.as_tensor(a))
    H = W = 224 // 7 * 7
    C, win = (192, 7)
    return {'x': _w((lambda *s: torch.randn(*s, dtype=torch.bfloat16) * 0.2)(1, H, W, C)), 'wqkv': _w((lambda *s: torch.randn(*s, dtype=torch.bfloat16) * 0.2)(C, 3 * C)), 'wo': _w((lambda *s: torch.randn(*s, dtype=torch.bfloat16) * 0.05)(C, C))}

def reference(x, wqkv, wo):
    B, H, W, C = x.shape
    win = 7
    nh, nw = (H // win, W // win)
    xw = (lambda x, *d: x.permute(*d))(x.reshape(B, nh, win, nw, win, C), 0, 1, 3, 2, 4, 5)
    xw = xw.reshape(B * nh * nw, win * win, C)
    qkv = xw @ wqkv
    q, k, v = (qkv[..., :C].clone(), qkv[..., C:2 * C].clone(), qkv[..., 2 * C:].clone())
    scale = C ** (-0.5)
    p = _softmax(torch.einsum('bqc,bkc->bqk', q, k) * scale, axis=-1)
    o = torch.einsum('bqk,bkc->bqc', p, v) @ wo
    o = (lambda x, *d: x.permute(*d))(o.reshape(B, nh, nw, win, win, C), 0, 1, 3, 2, 4, 5)
    return o.reshape(B, H, W, C)
```

```asm
; @launch grid=(256,1,1) block=(256,1,1) lds=163840
.amdgcn_target "amdgcn-amd-amdhsa--gfx950"
.text
.globl standalone__swin_window_attn__vision_kernel
.p2align 8
.type standalone__swin_window_attn__vision_kernel,@function
standalone__swin_window_attn__vision_kernel:
    s_load_dwordx8 s[4:11], s[0:1], 0
    s_load_dwordx4 s[12:15], s[0:1], 32
    s_cmp_ge_u32 s2, 256
    s_cbranch_scc1 L_end
    s_getpc_b64 s[74:75]
    s_lshr_b32 s50, s2, 3
    s_lshl_b32 s50, s50, 8
    v_add_u32 v12, s50, v0
    s_and_b32 s74, s74, 0xffffff00
    v_and_b32 v12, 2047, v12
    v_lshlrev_b32 v12, 4, v12
    v_min_u32 v12, L_cend-standalone__swin_window_attn__vision_kernel-16, v12
    global_load_dwordx4 v[244:247], v12, s[74:75]
    v_and_b32 v1, 63, v0
    v_lshrrev_b32 v12, 6, v0
    s_nop 0
    v_readfirstlane_b32 s40, v12
    v_lshlrev_b32 v7, 4, v1
    s_lshr_b32 s50, s2, 3
    s_and_b32 s51, s2, 7
    s_lshl_b32 s51, s51, 2
    s_add_u32 s51, s51, s40
    s_mul_i32 s50, s50, 602112
    s_mul_i32 s51, s51, 2688
    s_add_u32 s50, s50, s51
    s_mov_b32 s47, s50
    v_and_b32 v12, 15, v1
    v_lshrrev_b32 v13, 4, v1
    v_lshlrev_b32 v14, 4, v13
    v_add_u32 v14, s50, v14
    v_add_u32 v15, 0, v12
    v_mul_u32_u24 v2, 37, v15
    v_lshrrev_b32 v2, 8, v2
    v_mul_u32_u24 v2, 217, v2
    v_add_u32 v2, v2, v15
    v_mul_u32_u24 v2, 384, v2
    v_add_u32 v2, v2, v14
    v_add_u32 v15, 16, v12
    v_mul_u32_u24 v3, 37, v15
    v_lshrrev_b32 v3, 8, v3
    v_mul_u32_u24 v3, 217, v3
    v_add_u32 v3, v3, v15
    v_mul_u32_u24 v3, 384, v3
    v_add_u32 v3, v3, v14
    v_add_u32 v15, 32, v12
    v_mul_u32_u24 v4, 37, v15
    v_lshrrev_b32 v4, 8, v4
    v_mul_u32_u24 v4, 217, v4
    v_add_u32 v4, v4, v15
    v_mul_u32_u24 v4, 384, v4
    v_add_u32 v4, v4, v14
    v_add_u32 v5, 518400, v14
    s_lshl_b32 s74, s40, 8
    s_add_u32 s74, s74, s2
    s_mul_i32 s49, s40, 6144
    s_waitcnt lgkmcnt(0)
    s_mov_b32 s20, s6
    s_and_b32 s21, s7, 0xffff
    s_mov_b32 s22, 221184
    s_mov_b32 s23, 0x20000
    s_mov_b32 s16, s4
    s_and_b32 s17, s5, 0xffff
    s_mov_b32 s18, 19267584
    s_mov_b32 s19, 0x20000
    s_mov_b32 s28, s14
    s_and_b32 s29, s15, 0xffff
    s_mov_b32 s30, 147456
    s_mov_b32 s31, 0x20000
    s_mov_b32 s32, s8
    s_and_b32 s33, s9, 0xffff
    s_mov_b32 s34, 73728
    s_mov_b32 s35, 0x20000
    s_mov_b32 s36, s12
    s_and_b32 s37, s13, 0xffff
    s_mov_b32 s38, 256
    s_mov_b32 s39, 0x20000
    s_mov_b32 s77, 0
    s_cmp_ge_u32 s74, 72
    s_cbranch_scc1 L_np1
    s_setprio 3
    s_mov_b32 s77, 1
    s_cmp_ge_u32 s74, 36
    s_cbranch_scc1 L_pn
    s_mul_i32 s54, s74, 43
    s_lshr_b32 s54, s54, 8
    s_mul_i32 s52, s54, 6
    s_sub_u32 s55, s74, s52
    v_and_b32 v16, 15, v1
    v_lshrrev_b32 v17, 4, v1
    v_lshrrev_b32 v20, 2, v16
    v_and_b32 v19, 3, v16
    v_lshl_add_u32 v18, v20, 3, v19
    v_mul_u32_u24 v18, 1152, v18
    v_lshl_add_u32 v18, v17, 4, v18
    s_mul_i32 s52, s54, 36864
    v_add_u32 v19, s52, v18
    s_mul_i32 s52, s55, 36864
    v_add_u32 v18, s52, v18
    s_movk_i32 s53, 4608
    buffer_load_dwordx4 a[144:147], v18, s[20:23], 0 offen offset:0
    buffer_load_dwordx4 v[176:179], v19, s[20:23], 0 offen offset:384
    buffer_load_dwordx4 a[168:171], v18, s[20:23], s53 offen offset:0
    buffer_load_dwordx4 v[200:203], v19, s[20:23], s53 offen offset:384
    buffer_load_dwordx4 a[148:151], v18, s[20:23], 0 offen offset:64
    buffer_load_dwordx4 v[180:183], v19, s[20:23], 0 offen offset:448
    buffer_load_dwordx4 a[172:175], v18, s[20:23], s53 offen offset:64
    buffer_load_dwordx4 v[204:207], v19, s[20:23], s53 offen offset:448
    buffer_load_dwordx4 a[152:155], v18, s[20:23], 0 offen offset:128
    buffer_load_dwordx4 v[184:187], v19, s[20:23], 0 offen offset:512
    buffer_load_dwordx4 a[176:179], v18, s[20:23], s53 offen offset:128
    buffer_load_dwordx4 v[208:211], v19, s[20:23], s53 offen offset:512
    buffer_load_dwordx4 a[156:159], v18, s[20:23], 0 offen offset:192
    buffer_load_dwordx4 v[188:191], v19, s[20:23], 0 offen offset:576
    buffer_load_dwordx4 a[180:183], v18, s[20:23], s53 offen offset:192
    buffer_load_dwordx4 v[212:215], v19, s[20:23], s53 offen offset:576
    buffer_load_dwordx4 a[160:163], v18, s[20:23], 0 offen offset:256
    buffer_load_dwordx4 v[192:195], v19, s[20:23], 0 offen offset:640
    buffer_load_dwordx4 a[184:187], v18, s[20:23], s53 offen offset:256
    buffer_load_dwordx4 v[216:219], v19, s[20:23], s53 offen offset:640
    buffer_load_dwordx4 a[164:167], v18, s[20:23], 0 offen offset:320
    buffer_load_dwordx4 v[196:199], v19, s[20:23], 0 offen offset:704
    buffer_load_dwordx4 a[188:191], v18, s[20:23], s53 offen offset:320
    buffer_load_dwordx4 v[220:223], v19, s[20:23], s53 offen offset:704
    s_waitcnt vmcnt(0)
    v_mfma_f32_16x16x32_bf16 v[224:227], a[144:147], v[176:179], 0
    v_mfma_f32_16x16x32_bf16 v[228:231], a[168:171], v[176:179], 0
    v_mfma_f32_16x16x32_bf16 v[232:235], a[144:147], v[200:203], 0
    v_mfma_f32_16x16x32_bf16 v[236:239], a[168:171], v[200:203], 0
    v_mfma_f32_16x16x32_bf16 v[224:227], a[148:151], v[180:183], v[224:227]
    v_mfma_f32_16x16x32_bf16 v[228:231], a[172:175], v[180:183], v[228:231]
    v_mfma_f32_16x16x32_bf16 v[232:235], a[148:151], v[204:207], v[232:235]
    v_mfma_f32_16x16x32_bf16 v[236:239], a[172:175], v[204:207], v[236:239]
    v_mfma_f32_16x16x32_bf16 v[224:227], a[152:155], v[184:187], v[224:227]
    v_mfma_f32_16x16x32_bf16 v[228:231], a[176:179], v[184:187], v[228:231]
    v_mfma_f32_16x16x32_bf16 v[232:235], a[152:155], v[208:211], v[232:235]
    v_mfma_f32_16x16x32_bf16 v[236:239], a[176:179], v[208:211], v[236:239]
    v_mfma_f32_16x16x32_bf16 v[224:227], a[156:159], v[188:191], v[224:227]
    v_mfma_f32_16x16x32_bf16 v[228:231], a[180:183], v[188:191], v[228:231]
    v_mfma_f32_16x16x32_bf16 v[232:235], a[156:159], v[212:215], v[232:235]
    v_mfma_f32_16x16x32_bf16 v[236:239], a[180:183], v[212:215], v[236:239]
    v_mfma_f32_16x16x32_bf16 v[224:227], a[160:163], v[192:195], v[224:227]
    v_mfma_f32_16x16x32_bf16 v[228:231], a[184:187], v[192:195], v[228:231]
    v_mfma_f32_16x16x32_bf16 v[232:235], a[160:163], v[216:219], v[232:235]
    v_mfma_f32_16x16x32_bf16 v[236:239], a[184:187], v[216:219], v[236:239]
    v_mfma_f32_16x16x32_bf16 v[224:227], a[164:167], v[196:199], v[224:227]
    v_mfma_f32_16x16x32_bf16 v[228:231], a[188:191], v[196:199], v[228:231]
    v_mfma_f32_16x16x32_bf16 v[232:235], a[164:167], v[220:223], v[232:235]
    v_mfma_f32_16x16x32_bf16 v[236:239], a[188:191], v[220:223], v[236:239]
    s_mul_i32 s52, s54, 12288
    s_lshl_b32 s53, s55, 10
    s_add_u32 s52, s52, s53
    s_add_u32 s52, s52, 73728
    s_add_u32 s53, s52, 6144
    v_cvt_pk_bf16_f32 v240, v224, v225
    v_cvt_pk_bf16_f32 v241, v226, v227
    v_cvt_pk_bf16_f32 v242, v228, v229
    v_cvt_pk_bf16_f32 v243, v230, v231
    buffer_store_dwordx4 v[240:243], v7, s[28:31], s52 offen offset:0 sc1
    v_cvt_pk_bf16_f32 v244, v232, v233
    v_cvt_pk_bf16_f32 v245, v234, v235
    v_cvt_pk_bf16_f32 v246, v236, v237
    v_cvt_pk_bf16_f32 v247, v238, v239
    buffer_store_dwordx4 v[244:247], v7, s[28:31], s53 offen offset:0 sc1
    s_nop 1
    s_waitcnt vmcnt(0)
    v_mov_b32 v16, 1
    s_mov_b64 exec, 1
    buffer_atomic_add v16, off, s[36:39], 0 offset:64 sc0 sc1
    s_barrier
    s_waitcnt vmcnt(0)
    v_readfirstlane_b32 s52, v16
    v_mov_b32 v16, 0x01010101
    s_cmp_lg_u32 s52, 35
    s_cbranch_scc1 L_nl
    buffer_store_dword v16, off, s[36:39], 0 offset:128 sc1
L_nl:
    s_mov_b64 exec, -1
    s_setprio 0
    s_branch L_np1
L_pn:
    s_sub_u32 s74, s74, 36
    s_mov_b32 s77, 1
    s_mul_i32 s54, s74, 43
    s_lshr_b32 s54, s54, 8
    s_mul_i32 s52, s54, 6
    s_sub_u32 s55, s74, s52
    v_and_b32 v16, 15, v1
    v_lshrrev_b32 v17, 4, v1
    v_lshrrev_b32 v20, 2, v16
    v_and_b32 v19, 3, v16
    v_lshl_add_u32 v18, v20, 3, v19
    v_mul_u32_u24 v18, 1152, v18
    v_lshl_add_u32 v18, v17, 4, v18
    s_mul_i32 s52, s55, 36864
    v_add_u32 v18, s52, v18
    v_lshl_add_u32 v21, v17, 3, v20
    v_lshlrev_b32 v21, 6, v21
    v_lshl_add_u32 v21, v19, 4, v21
    v_add_u32 v21, 147456, v21
    v_lshrrev_b32 v20, 2, v1
    v_mul_u32_u24 v20, 384, v20
    v_and_b32 v19, 3, v1
    v_lshl_add_u32 v19, v19, 4, v20
    s_lshl_b32 s52, s54, 6
    v_add_u32 v19, s52, v19
    s_movk_i32 s53, 4608
    s_mov_b32 s52, 0
    s_mov_b32 m0, 147456
    s_nop 0
    buffer_load_dwordx4 v19, s[32:35], s52 offen lds
    s_mov_b32 s52, 6144
    s_mov_b32 m0, 148480
    s_nop 0
    buffer_load_dwordx4 v19, s[32:35], s52 offen lds
    s_mov_b32 s52, 12288
    s_mov_b32 m0, 149504
    s_nop 0
    buffer_load_dwordx4 v19, s[32:35], s52 offen lds
    s_mov_b32 s52, 18432
    s_mov_b32 m0, 150528
    s_nop 0
    buffer_load_dwordx4 v19, s[32:35], s52 offen lds
    s_mov_b32 s52, 24576
    s_mov_b32 m0, 151552
    s_nop 0
    buffer_load_dwordx4 v19, s[32:35], s52 offen lds
    s_mov_b32 s52, 30720
    s_mov_b32 m0, 152576
    s_nop 0
    buffer_load_dwordx4 v19, s[32:35], s52 offen lds
    s_mov_b32 s52, 36864
    s_mov_b32 m0, 153600
    s_nop 0
    buffer_load_dwordx4 v19, s[32:35], s52 offen lds
    s_mov_b32 s52, 43008
    s_mov_b32 m0, 154624
    s_nop 0
    buffer_load_dwordx4 v19, s[32:35], s52 offen lds
    s_mov_b32 s52, 49152
    s_mov_b32 m0, 155648
    s_nop 0
    buffer_load_dwordx4 v19, s[32:35], s52 offen lds
    s_mov_b32 s52, 55296
    s_mov_b32 m0, 156672
    s_nop 0
    buffer_load_dwordx4 v19, s[32:35], s52 offen lds
    s_mov_b32 s52, 61440
    s_mov_b32 m0, 157696
    s_nop 0
    buffer_load_dwordx4 v19, s[32:35], s52 offen lds
    s_mov_b32 s52, 67584
    s_mov_b32 m0, 158720
    s_nop 0
    buffer_load_dwordx4 v19, s[32:35], s52 offen lds
    buffer_load_dwordx4 a[144:147], v18, s[20:23], 0 offen offset:768
    buffer_load_dwordx4 a[168:171], v18, s[20:23], s53 offen offset:768
    buffer_load_dwordx4 a[148:151], v18, s[20:23], 0 offen offset:832
    buffer_load_dwordx4 a[172:175], v18, s[20:23], s53 offen offset:832
    buffer_load_dwordx4 a[152:155], v18, s[20:23], 0 offen offset:896
    buffer_load_dwordx4 a[176:179], v18, s[20:23], s53 offen offset:896
    buffer_load_dwordx4 a[156:159], v18, s[20:23], 0 offen offset:960
    buffer_load_dwordx4 a[180:183], v18, s[20:23], s53 offen offset:960
    buffer_load_dwordx4 a[160:163], v18, s[20:23], 0 offen offset:1024
    buffer_load_dwordx4 a[184:187], v18, s[20:23], s53 offen offset:1024
    buffer_load_dwordx4 a[164:167], v18, s[20:23], 0 offen offset:1088
    buffer_load_dwordx4 a[188:191], v18, s[20:23], s53 offen offset:1088
    s_waitcnt vmcnt(0)
    ds_read_b64_tr_b16 v[176:177], v21 offset:0
    ds_read_b64_tr_b16 v[178:179], v21 offset:256
    ds_read_b64_tr_b16 v[200:201], v21 offset:8
    ds_read_b64_tr_b16 v[202:203], v21 offset:264
    ds_read_b64_tr_b16 v[180:181], v21 offset:2048
    ds_read_b64_tr_b16 v[182:183], v21 offset:2304
    ds_read_b64_tr_b16 v[204:205], v21 offset:2056
    ds_read_b64_tr_b16 v[206:207], v21 offset:2312
    ds_read_b64_tr_b16 v[184:185], v21 offset:4096
    ds_read_b64_tr_b16 v[186:187], v21 offset:4352
    ds_read_b64_tr_b16 v[208:209], v21 offset:4104
    ds_read_b64_tr_b16 v[210:211], v21 offset:4360
    ds_read_b64_tr_b16 v[188:189], v21 offset:6144
    ds_read_b64_tr_b16 v[190:191], v21 offset:6400
    ds_read_b64_tr_b16 v[212:213], v21 offset:6152
    ds_read_b64_tr_b16 v[214:215], v21 offset:6408
    ds_read_b64_tr_b16 v[192:193], v21 offset:8192
    ds_read_b64_tr_b16 v[194:195], v21 offset:8448
    ds_read_b64_tr_b16 v[216:217], v21 offset:8200
    ds_read_b64_tr_b16 v[218:219], v21 offset:8456
    ds_read_b64_tr_b16 v[196:197], v21 offset:10240
    ds_read_b64_tr_b16 v[198:199], v21 offset:10496
    ds_read_b64_tr_b16 v[220:221], v21 offset:10248
    ds_read_b64_tr_b16 v[222:223], v21 offset:10504
    s_waitcnt lgkmcnt(15)
    v_mfma_f32_16x16x32_bf16 v[224:227], a[144:147], v[176:179], 0
    v_mfma_f32_16x16x32_bf16 v[228:231], a[168:171], v[176:179], 0
    v_mfma_f32_16x16x32_bf16 v[232:235], a[144:147], v[200:203], 0
    v_mfma_f32_16x16x32_bf16 v[236:239], a[168:171], v[200:203], 0
    v_mfma_f32_16x16x32_bf16 v[224:227], a[148:151], v[180:183], v[224:227]
    v_mfma_f32_16x16x32_bf16 v[228:231], a[172:175], v[180:183], v[228:231]
    v_mfma_f32_16x16x32_bf16 v[232:235], a[148:151], v[204:207], v[232:235]
    v_mfma_f32_16x16x32_bf16 v[236:239], a[172:175], v[204:207], v[236:239]
    s_waitcnt lgkmcnt(14)
    v_mfma_f32_16x16x32_bf16 v[224:227], a[152:155], v[184:187], v[224:227]
    v_mfma_f32_16x16x32_bf16 v[228:231], a[176:179], v[184:187], v[228:231]
    s_waitcnt lgkmcnt(12)
    v_mfma_f32_16x16x32_bf16 v[232:235], a[152:155], v[208:211], v[232:235]
    v_mfma_f32_16x16x32_bf16 v[236:239], a[176:179], v[208:211], v[236:239]
    s_waitcnt lgkmcnt(10)
    v_mfma_f32_16x16x32_bf16 v[224:227], a[156:159], v[188:191], v[224:227]
    v_mfma_f32_16x16x32_bf16 v[228:231], a[180:183], v[188:191], v[228:231]
    s_waitcnt lgkmcnt(8)
    v_mfma_f32_16x16x32_bf16 v[232:235], a[156:159], v[212:215], v[232:235]
    v_mfma_f32_16x16x32_bf16 v[236:239], a[180:183], v[212:215], v[236:239]
    s_waitcnt lgkmcnt(6)
    v_mfma_f32_16x16x32_bf16 v[224:227], a[160:163], v[192:195], v[224:227]
    v_mfma_f32_16x16x32_bf16 v[228:231], a[184:187], v[192:195], v[228:231]
    s_waitcnt lgkmcnt(4)
    v_mfma_f32_16x16x32_bf16 v[232:235], a[160:163], v[216:219], v[232:235]
    v_mfma_f32_16x16x32_bf16 v[236:239], a[184:187], v[216:219], v[236:239]
    s_waitcnt lgkmcnt(2)
    v_mfma_f32_16x16x32_bf16 v[224:227], a[164:167], v[196:199], v[224:227]
    v_mfma_f32_16x16x32_bf16 v[228:231], a[188:191], v[196:199], v[228:231]
    s_waitcnt lgkmcnt(0)
    v_mfma_f32_16x16x32_bf16 v[232:235], a[164:167], v[220:223], v[232:235]
    v_mfma_f32_16x16x32_bf16 v[236:239], a[188:191], v[220:223], v[236:239]
    s_mul_i32 s52, s54, 12288
    s_lshl_b32 s53, s55, 10
    s_add_u32 s52, s52, s53
    s_add_u32 s53, s52, 6144
    v_cvt_pk_bf16_f32 v240, v224, v225
    v_cvt_pk_bf16_f32 v241, v226, v227
    v_cvt_pk_bf16_f32 v242, v228, v229
    v_cvt_pk_bf16_f32 v243, v230, v231
    buffer_store_dwordx4 v[240:243], v7, s[28:31], s52 offen offset:0 sc1
    v_cvt_pk_bf16_f32 v244, v232, v233
    v_cvt_pk_bf16_f32 v245, v234, v235
    v_cvt_pk_bf16_f32 v246, v236, v237
    v_cvt_pk_bf16_f32 v247, v238, v239
    buffer_store_dwordx4 v[244:247], v7, s[28:31], s53 offen offset:0 sc1
    s_nop 1
    s_waitcnt vmcnt(0)
    v_mov_b32 v16, 1
    s_mov_b64 exec, 1
    buffer_atomic_add v16, off, s[36:39], 0 offset:0 sc0 sc1
    s_barrier
    s_waitcnt vmcnt(0)
    v_readfirstlane_b32 s52, v16
    v_mov_b32 v16, 0x01010101
    s_cmp_lg_u32 s52, 35
    s_cbranch_scc1 L_nl2
    buffer_store_dword v16, off, s[36:39], 0 offset:132 sc1
L_nl2:
    s_mov_b64 exec, -1
    s_setprio 0
L_np1:
    s_mov_b32 s70, -1
    s_movk_i32 s71, 0xff
    v_lshrrev_b32 v205, 3, v1
    v_lshlrev_b32 v203, 7, v205
    v_add_u32 v203, s47, v203
    v_and_b32 v204, 7, v1
    v_add_u32 v206, 0, v205
    v_mul_u32_u24 v206, 43, v206
    v_lshrrev_b32 v200, 7, v206
    v_add_u32 v206, 8, v205
    v_mul_u32_u24 v206, 43, v206
    v_lshrrev_b32 v201, 7, v206
    v_add_u32 v206, 16, v205
    v_mul_u32_u24 v206, 43, v206
    v_lshrrev_b32 v202, 7, v206
    s_mul_i32 s68, s40, 10752
    s_lshl_b32 s69, s40, 13
    s_add_u32 s69, s69, 49152
    s_nop 4
    s_cmp_eq_u32 s77, 1
    s_cbranch_scc1 L_pw
    s_mov_b32 s50, 0
    s_add_u32 m0, s68, 0
    v_add_u32 v205, 0, v200
    v_bfe_u32 v205, v205, 1, 3
    v_xor_b32 v205, v205, v204
    v_lshl_add_u32 v205, v205, 4, v203
    buffer_load_dwordx4 v205, s[16:19], s50 offen offset:0 nt lds
    v_add_u32 v206, 0, v201
    v_bfe_u32 v206, v206, 1, 3
    v_xor_b32 v206, v206, v204
    v_lshl_add_u32 v206, v206, 4, v203
    buffer_load_dwordx4 v206, s[16:19], s50 offen offset:1024 nt lds
    v_add_u32 v207, 0, v202
    v_bfe_u32 v207, v207, 1, 3
    v_xor_b32 v207, v207, v204
    v_lshl_add_u32 v207, v207, 4, v203
    s_mov_b64 exec, s[70:71]
    buffer_load_dwordx4 v207, s[16:19], s50 offen offset:2048 nt lds
    s_mov_b64 exec, -1
    s_mov_b32 s50, 86016
    s_add_u32 m0, s68, 2688
    v_add_u32 v205, 7, v200
    v_bfe_u32 v205, v205, 1, 3
    v_xor_b32 v205, v205, v204
    v_lshl_add_u32 v205, v205, 4, v203
    buffer_load_dwordx4 v205, s[16:19], s50 offen offset:0 nt lds
    v_add_u32 v206, 7, v201
    v_bfe_u32 v206, v206, 1, 3
    v_xor_b32 v206, v206, v204
    v_lshl_add_u32 v206, v206, 4, v203
    buffer_load_dwordx4 v206, s[16:19], s50 offen offset:1024 nt lds
    v_add_u32 v207, 7, v202
    v_bfe_u32 v207, v207, 1, 3
    v_xor_b32 v207, v207, v204
    v_lshl_add_u32 v207, v207, 4, v203
    s_mov_b64 exec, s[70:71]
    buffer_load_dwordx4 v207, s[16:19], s50 offen offset:2048 nt lds
    s_mov_b64 exec, -1
    s_cmp_ge_u32 s2, 72
    s_cbranch_scc1 L_x2
    s_barrier
    s_branch L_x2
L_pw:
    s_mov_b32 s50, 0
    s_add_u32 m0, s68, 0
    v_add_u32 v205, 0, v200
    v_bfe_u32 v205, v205, 1, 3
    v_xor_b32 v205, v205, v204
    v_lshl_add_u32 v205, v205, 4, v203
    buffer_load_dwordx4 v205, s[16:19], s50 offen offset:0 nt lds
    v_add_u32 v206, 0, v201
    v_bfe_u32 v206, v206, 1, 3
    v_xor_b32 v206, v206, v204
    v_lshl_add_u32 v206, v206, 4, v203
    buffer_load_dwordx4 v206, s[16:19], s50 offen offset:1024 nt lds
    v_add_u32 v207, 0, v202
    v_bfe_u32 v207, v207, 1, 3
    v_xor_b32 v207, v207, v204
    v_lshl_add_u32 v207, v207, 4, v203
    s_mov_b64 exec, s[70:71]
    buffer_load_dwordx4 v207, s[16:19], s50 offen offset:2048 nt lds
    s_mov_b64 exec, -1
    s_mov_b32 s50, 86016
    s_add_u32 m0, s68, 2688
    v_add_u32 v205, 7, v200
    v_bfe_u32 v205, v205, 1, 3
    v_xor_b32 v205, v205, v204
    v_lshl_add_u32 v205, v205, 4, v203
    buffer_load_dwordx4 v205, s[16:19], s50 offen offset:0 nt lds
    v_add_u32 v206, 7, v201
    v_bfe_u32 v206, v206, 1, 3
    v_xor_b32 v206, v206, v204
    v_lshl_add_u32 v206, v206, 4, v203
    buffer_load_dwordx4 v206, s[16:19], s50 offen offset:1024 nt lds
    v_add_u32 v207, 7, v202
    v_bfe_u32 v207, v207, 1, 3
    v_xor_b32 v207, v207, v204
    v_lshl_add_u32 v207, v207, 4, v203
    s_mov_b64 exec, s[70:71]
    buffer_load_dwordx4 v207, s[16:19], s50 offen offset:2048 nt lds
    s_mov_b64 exec, -1
L_x2:
    s_mov_b32 s50, 172032
    s_add_u32 m0, s68, 5376
    v_add_u32 v205, 14, v200
    v_bfe_u32 v205, v205, 1, 3
    v_xor_b32 v205, v205, v204
    v_lshl_add_u32 v205, v205, 4, v203
    buffer_load_dwordx4 v205, s[16:19], s50 offen offset:0 nt lds
    v_add_u32 v206, 14, v201
    v_bfe_u32 v206, v206, 1, 3
    v_xor_b32 v206, v206, v204
    v_lshl_add_u32 v206, v206, 4, v203
    buffer_load_dwordx4 v206, s[16:19], s50 offen offset:1024 nt lds
    v_add_u32 v207, 14, v202
    v_bfe_u32 v207, v207, 1, 3
    v_xor_b32 v207, v207, v204
    v_lshl_add_u32 v207, v207, 4, v203
    s_mov_b64 exec, s[70:71]
    buffer_load_dwordx4 v207, s[16:19], s50 offen offset:2048 nt lds
    s_mov_b64 exec, -1
    s_mov_b32 s50, 258048
    s_add_u32 m0, s68, 8064
    v_add_u32 v205, 21, v200
    v_bfe_u32 v205, v205, 1, 3
    v_xor_b32 v205, v205, v204
    v_lshl_add_u32 v205, v205, 4, v203
    buffer_load_dwordx4 v205, s[16:19], s50 offen offset:0 nt lds
    v_add_u32 v206, 21, v201
    v_bfe_u32 v206, v206, 1, 3
    v_xor_b32 v206, v206, v204
    v_lshl_add_u32 v206, v206, 4, v203
    buffer_load_dwordx4 v206, s[16:19], s50 offen offset:1024 nt lds
    v_add_u32 v207, 21, v202
    v_bfe_u32 v207, v207, 1, 3
    v_xor_b32 v207, v207, v204
    v_lshl_add_u32 v207, v207, 4, v203
    s_mov_b64 exec, s[70:71]
    buffer_load_dwordx4 v207, s[16:19], s50 offen offset:2048 nt lds
    s_mov_b64 exec, -1
    s_mov_b32 s50, 344064
    s_add_u32 m0, s69, 0
    v_add_u32 v205, 28, v200
    v_bfe_u32 v205, v205, 1, 3
    v_xor_b32 v205, v205, v204
    v_lshl_add_u32 v205, v205, 4, v203
    buffer_load_dwordx4 v205, s[16:19], s50 offen offset:0 nt lds
    v_add_u32 v206, 28, v201
    v_bfe_u32 v206, v206, 1, 3
    v_xor_b32 v206, v206, v204
    v_lshl_add_u32 v206, v206, 4, v203
    buffer_load_dwordx4 v206, s[16:19], s50 offen offset:1024 nt lds
    v_add_u32 v207, 28, v202
    v_bfe_u32 v207, v207, 1, 3
    v_xor_b32 v207, v207, v204
    v_lshl_add_u32 v207, v207, 4, v203
    s_mov_b64 exec, s[70:71]
    buffer_load_dwordx4 v207, s[16:19], s50 offen offset:2048 nt lds
    s_mov_b64 exec, -1
    s_mov_b32 s50, 430080
    s_add_u32 m0, s69, 2688
    v_add_u32 v205, 35, v200
    v_bfe_u32 v205, v205, 1, 3
    v_xor_b32 v205, v205, v204
    v_lshl_add_u32 v205, v205, 4, v203
    buffer_load_dwordx4 v205, s[16:19], s50 offen offset:0 nt lds
    v_add_u32 v206, 35, v201
    v_bfe_u32 v206, v206, 1, 3
    v_xor_b32 v206, v206, v204
    v_lshl_add_u32 v206, v206, 4, v203
    buffer_load_dwordx4 v206, s[16:19], s50 offen offset:1024 nt lds
    v_add_u32 v207, 35, v202
    v_bfe_u32 v207, v207, 1, 3
    v_xor_b32 v207, v207, v204
    v_lshl_add_u32 v207, v207, 4, v203
    s_mov_b64 exec, s[70:71]
    buffer_load_dwordx4 v207, s[16:19], s50 offen offset:2048 nt lds
    s_mov_b64 exec, -1
    s_mov_b32 s50, 516096
    s_add_u32 m0, s69, 5376
    v_add_u32 v205, 42, v200
    v_bfe_u32 v205, v205, 1, 3
    v_xor_b32 v205, v205, v204
    v_lshl_add_u32 v205, v205, 4, v203
    buffer_load_dwordx4 v205, s[16:19], s50 offen offset:0 nt lds
    v_add_u32 v206, 42, v201
    v_bfe_u32 v206, v206, 1, 3
    v_xor_b32 v206, v206, v204
    v_lshl_add_u32 v206, v206, 4, v203
    buffer_load_dwordx4 v206, s[16:19], s50 offen offset:1024 nt lds
    v_add_u32 v207, 42, v202
    v_bfe_u32 v207, v207, 1, 3
    v_xor_b32 v207, v207, v204
    v_lshl_add_u32 v207, v207, 4, v203
    s_mov_b64 exec, s[70:71]
    buffer_load_dwordx4 v207, s[16:19], s50 offen offset:2048 nt lds
    s_mov_b64 exec, -1
    s_mov_b32 s24, s10
    s_and_b32 s25, s11, 0xffff
    s_mov_b32 s26, 19267584
    s_mov_b32 s27, 0x20000
    s_lshl_b32 s52, s40, 2
    v_cmp_eq_u32 vcc, s52, v12
    v_mov_b32 v6, 2130706432
    s_nop 0
    v_cndmask_b32 v6, v6, v5, vcc
    v_mov_b32 v8, v7
    v_add_u32 v9, 49152, v7
    v_add_u32 v10, 98304, v7
    v_add_u32 v11, s49, v7
    v_mov_b32 v22, 0
    v_mov_b32 v15, 4286578688
    s_mov_b32 s42, 0x3dd53b95
    s_mov_b32 s43, s42
    s_mov_b64 s[44:45], 0xffff
    s_lshl_b32 s52, s40, 4
    s_lshl_b64 s[44:45], s[44:45], s52
    v_add_u32 v31, s69, v7
    s_sub_u32 s52, s69, 10752
    v_lshrrev_b32 v205, 1, v12
    v_xor_b32 v205, v205, v13
    v_lshlrev_b32 v205, 4, v205
    v_mul_u32_u24 v206, 384, v12
    v_add_u32 v205, v205, v206
    v_add_u32 v248, s68, v205
    v_add_u32 v252, s52, v205
    v_cmp_gt_u32 vcc, 12, v12
    s_nop 1
    v_cndmask_b32 v250, v252, v248, vcc
    v_add_u32 v250, 6144, v250
    v_add_u32 v252, 12288, v252
    v_lshlrev_b32 v206, 4, v13
    v_lshrrev_b32 v205, 2, v12
    v_lshl_add_u32 v206, v205, 13, v206
    v_add_u32 v254, 56832, v206
    v_add_u32 v25, 81920, v11
    v_xor_b32 v249, 64, v248
    v_xor_b32 v251, 64, v250
    v_xor_b32 v253, 64, v252
    v_xor_b32 v255, 64, v254
    s_cmp_lg_u32 s40, 0
    s_cbranch_scc1 L_npA
    s_waitcnt vmcnt(0)
    buffer_load_dword v16, off, s[36:39], 0 offset:128 sc1
L_npA:
    s_cmp_lg_u32 s40, 0
    s_cbranch_scc1 L_wx
    s_waitcnt vmcnt(0)
    v_cmp_ne_u32 vcc, 0x01010101, v16
    s_nop 0
    s_cmp_eq_u64 vcc, 0
    s_cbranch_scc1 L_okM
    s_branch L_slowM
L_wx:
    s_waitcnt vmcnt(0)
L_okM:
    s_barrier
    s_mov_b32 s50, 73728
    s_add_u32 m0, s49, 81920
    ds_read_b128 a[0:3], v248 offset:0
    buffer_load_dwordx4 v11, s[28:31], s50 offen offset:0 sc1 lds
    buffer_load_dwordx4 v11, s[28:31], s50 offen offset:1024 sc1 lds
    buffer_load_dwordx4 v11, s[28:31], s50 offen offset:2048 sc1 lds
    buffer_load_dwordx4 v11, s[28:31], s50 offen offset:3072 sc1 lds
    s_mov_b32 s50, 77824
    s_add_u32 m0, s49, 86016
    ds_read_b128 a[24:27], v250 offset:0
    buffer_load_dwordx4 v11, s[28:31], s50 offen offset:0 sc1 lds
    buffer_load_dwordx4 v11, s[28:31], s50 offen offset:1024 sc1 lds
    s_mov_b32 s50, 98304
    s_add_u32 m0, s49, 106496
    ds_read_b128 a[48:51], v252 offset:0
    buffer_load_dwordx4 v11, s[28:31], s50 offen offset:0 sc1 lds
    buffer_load_dwordx4 v11, s[28:31], s50 offen offset:1024 sc1 lds
    buffer_load_dwordx4 v11, s[28:31], s50 offen offset:2048 sc1 lds
    buffer_load_dwordx4 v11, s[28:31], s50 offen offset:3072 sc1 lds
    s_mov_b32 s50, 102400
    s_add_u32 m0, s49, 110592
    ds_read_b128 a[72:75], v254 offset:0
    buffer_load_dwordx4 v11, s[28:31], s50 offen offset:0 sc1 lds
    buffer_load_dwordx4 v11, s[28:31], s50 offen offset:1024 sc1 lds
    s_mov_b32 s50, 122880
    s_add_u32 m0, s49, 131072
    ds_read_b128 a[4:7], v249 offset:0
    buffer_load_dwordx4 v11, s[28:31], s50 offen offset:0 sc1 lds
    buffer_load_dwordx4 v11, s[28:31], s50 offen offset:1024 sc1 lds
    buffer_load_dwordx4 v11, s[28:31], s50 offen offset:2048 sc1 lds
    buffer_load_dwordx4 v11, s[28:31], s50 offen offset:3072 sc1 lds
    s_mov_b32 s50, 126976
    s_add_u32 m0, s49, 135168
    ds_read_b128 a[28:31], v251 offset:0
    buffer_load_dwordx4 v11, s[28:31], s50 offen offset:0 sc1 lds
    buffer_load_dwordx4 v11, s[28:31], s50 offen offset:1024 sc1 lds
    ds_read_b128 a[52:55], v253 offset:0
    ds_read_b128 a[76:79], v255 offset:0
    ds_read_b128 a[8:11], v248 offset:128
    ds_read_b128 a[32:35], v250 offset:128
    ds_read_b128 a[56:59], v252 offset:128
    ds_read_b128 a[80:83], v254 offset:128
    ds_read_b128 a[12:15], v249 offset:128
    ds_read_b128 a[36:39], v251 offset:128
    ds_read_b128 a[60:63], v253 offset:128
    ds_read_b128 a[84:87], v255 offset:128
    ds_read_b128 a[16:19], v248 offset:256
    ds_read_b128 a[40:43], v250 offset:256
    ds_read_b128 a[64:67], v252 offset:256
    ds_read_b128 a[88:91], v254 offset:256
    ds_read_b128 a[20:23], v249 offset:256
    ds_read_b128 a[44:47], v251 offset:256
    ds_read_b128 a[68:71], v253 offset:256
    ds_read_b128 a[92:95], v255 offset:256
    s_waitcnt vmcnt(12)
    s_barrier
    buffer_load_dword v23, v22, s[36:39], 0 offen offset:132 sc1
    ds_read_b128 a[96:99], v9 offset:32768
    ds_read_b128 a[100:103], v9 offset:33792
    ds_read_b128 a[104:107], v9 offset:34816
    ds_read_b128 a[108:111], v9 offset:35840
    ds_read_b128 a[112:115], v9 offset:36864
    ds_read_b128 a[116:119], v9 offset:37888
    v_lshlrev_b32 v27, 3, v1
    s_lshl_b32 s50, s40, 9
    v_add_u32 v27, 73728, v27
    ds_read_b128 a[120:123], v9 offset:38912
    v_add_u32 v26, s50, v27
    ds_read_b128 a[124:127], v9 offset:39936
    ds_read_b128 a[128:131], v9 offset:40960
    ds_read_b128 a[132:135], v9 offset:41984
    ds_read_b128 a[136:139], v9 offset:43008
    ds_read_b128 a[140:143], v9 offset:44032
    s_waitcnt lgkmcnt(11)
    v_mfma_f32_16x16x32_bf16 v[96:99], a[96:99], a[0:3], 0
    v_mfma_f32_16x16x32_bf16 v[100:103], a[96:99], a[24:27], 0
    v_mfma_f32_16x16x32_bf16 v[104:107], a[96:99], a[48:51], 0
    s_waitcnt lgkmcnt(10)
    v_mfma_f32_16x16x32_bf16 v[96:99], a[100:103], a[4:7], v[96:99]
    v_mfma_f32_16x16x32_bf16 v[100:103], a[100:103], a[28:31], v[100:103]
    v_mfma_f32_16x16x32_bf16 v[104:107], a[100:103], a[52:55], v[104:107]
    s_waitcnt lgkmcnt(9)
    v_mfma_f32_16x16x32_bf16 v[96:99], a[104:107], a[8:11], v[96:99]
    v_mfma_f32_16x16x32_bf16 v[100:103], a[104:107], a[32:35], v[100:103]
    ds_read_b128 a[96:99], v9 offset:45056
    ds_read_b128 a[100:103], v9 offset:46080
    v_mfma_f32_16x16x32_bf16 v[104:107], a[104:107], a[56:59], v[104:107]
    ds_read_b128 a[104:107], v9 offset:47104
    s_waitcnt lgkmcnt(11)
    v_mfma_f32_16x16x32_bf16 v[96:99], a[108:111], a[12:15], v[96:99]
    v_mfma_f32_16x16x32_bf16 v[100:103], a[108:111], a[36:39], v[100:103]
    v_mfma_f32_16x16x32_bf16 v[104:107], a[108:111], a[60:63], v[104:107]
    ds_read_b128 a[108:111], v9 offset:48128
    s_waitcnt lgkmcnt(11)
    v_mfma_f32_16x16x32_bf16 v[96:99], a[112:115], a[16:19], v[96:99]
    v_mfma_f32_16x16x32_bf16 v[100:103], a[112:115], a[40:43], v[100:103]
    v_mfma_f32_16x16x32_bf16 v[104:107], a[112:115], a[64:67], v[104:107]
    ds_read_b128 a[112:115], v10 offset:0
    s_waitcnt lgkmcnt(11)
    v_mfma_f32_16x16x32_bf16 v[96:99], a[116:119], a[20:23], v[96:99]
    v_mfma_f32_16x16x32_bf16 v[100:103], a[116:119], a[44:47], v[100:103]
    v_mfma_f32_16x16x32_bf16 v[104:107], a[116:119], a[68:71], v[104:107]
    ds_read_b128 a[116:119], v10 offset:1024
    s_waitcnt lgkmcnt(11)
    v_mfma_f32_16x16x32_bf16 v[112:115], a[120:123], a[0:3], 0
    v_mfma_f32_16x16x32_bf16 v[116:119], a[120:123], a[24:27], 0
    v_mfma_f32_16x16x32_bf16 v[120:123], a[120:123], a[48:51], 0
    ds_read_b128 a[120:123], v10 offset:2048
    s_waitcnt lgkmcnt(11)
    v_mfma_f32_16x16x32_bf16 v[112:115], a[124:127], a[4:7], v[112:115]
    v_cvt_pk_bf16_f32 v128, v96, v97
    v_cvt_pk_bf16_f32 v129, v98, v99
    v_mfma_f32_16x16x32_bf16 v[116:119], a[124:127], a[28:31], v[116:119]
    v_cvt_pk_bf16_f32 v132, v100, v101
    v_cvt_pk_bf16_f32 v133, v102, v103
    v_mfma_f32_16x16x32_bf16 v[120:123], a[124:127], a[52:55], v[120:123]
    v_cvt_pk_bf16_f32 v136, v104, v105
    v_cvt_pk_bf16_f32 v137, v106, v107
    s_waitcnt lgkmcnt(10)
    v_mfma_f32_16x16x32_bf16 v[112:115], a[128:131], a[8:11], v[112:115]
    ds_read_b128 a[124:127], v10 offset:3072
    v_mfma_f32_16x16x32_bf16 v[116:119], a[128:131], a[32:35], v[116:119]
    v_mfma_f32_16x16x32_bf16 v[120:123], a[128:131], a[56:59], v[120:123]
    ds_read_b128 a[128:131], v10 offset:4096
    s_waitcnt lgkmcnt(11)
    v_mfma_f32_16x16x32_bf16 v[112:115], a[132:135], a[12:15], v[112:115]
    v_mfma_f32_16x16x32_bf16 v[116:119], a[132:135], a[36:39], v[116:119]
    v_mfma_f32_16x16x32_bf16 v[120:123], a[132:135], a[60:63], v[120:123]
    ds_read_b128 a[132:135], v10 offset:5120
    s_waitcnt lgkmcnt(11)
    v_mfma_f32_16x16x32_bf16 v[112:115], a[136:139], a[16:19], v[112:115]
    v_mfma_f32_16x16x32_bf16 v[116:119], a[136:139], a[40:43], v[116:119]
    v_mfma_f32_16x16x32_bf16 v[120:123], a[136:139], a[64:67], v[120:123]
    ds_read_b128 a[136:139], v10 offset:6144
    s_waitcnt lgkmcnt(11)
    v_mfma_f32_16x16x32_bf16 v[112:115], a[140:143], a[20:23], v[112:115]
    v_mfma_f32_16x16x32_bf16 v[116:119], a[140:143], a[44:47], v[116:119]
    v_mfma_f32_16x16x32_bf16 v[120:123], a[140:143], a[68:71], v[120:123]
    ds_read_b128 a[140:143], v10 offset:7168
    s_waitcnt lgkmcnt(11)
    v_mfma_f32_16x16x32_bf16 v[96:99], a[96:99], a[0:3], 0
    v_mfma_f32_16x16x32_bf16 v[100:103], a[96:99], a[24:27], 0
    v_mfma_f32_16x16x32_bf16 v[104:107], a[96:99], a[48:51], 0
    s_waitcnt lgkmcnt(10)
    v_mfma_f32_16x16x32_bf16 v[96:99], a[100:103], a[4:7], v[96:99]
    v_mfma_f32_16x16x32_bf16 v[100:103], a[100:103], a[28:31], v[100:103]
    v_mfma_f32_16x16x32_bf16 v[104:107], a[100:103], a[52:55], v[104:107]
    s_waitcnt lgkmcnt(9)
    v_mfma_f32_16x16x32_bf16 v[96:99], a[104:107], a[8:11], v[96:99]
    v_mfma_f32_16x16x32_bf16 v[100:103], a[104:107], a[32:35], v[100:103]
    v_mfma_f32_16x16x32_bf16 v[104:107], a[104:107], a[56:59], v[104:107]
    s_waitcnt lgkmcnt(8)
    v_mfma_f32_16x16x32_bf16 v[96:99], a[108:111], a[12:15], v[96:99]
    s_waitcnt vmcnt(0)
    v_cmp_ne_u32 vcc, 16843009, v23
    v_mfma_f32_16x16x32_bf16 v[100:103], a[108:111], a[36:39], v[100:103]
    s_cmp_eq_u64 vcc, 0
    s_cselect_b32 s52, 1, s40
    v_mfma_f32_16x16x32_bf16 v[104:107], a[108:111], a[60:63], v[104:107]
    s_cmp_eq_u32 s52, 0
    s_cbranch_scc1 L_slowN
L_okN:
    s_waitcnt lgkmcnt(7)
    v_mfma_f32_16x16x32_bf16 v[96:99], a[112:115], a[16:19], v[96:99]
    s_barrier
    v_mfma_f32_16x16x32_bf16 v[100:103], a[112:115], a[40:43], v[100:103]
    v_cvt_pk_bf16_f32 v130, v112, v113
    v_cvt_pk_bf16_f32 v131, v114, v115
    v_mfma_f32_16x16x32_bf16 v[104:107], a[112:115], a[64:67], v[104:107]
    v_cvt_pk_bf16_f32 v134, v116, v117
    v_cvt_pk_bf16_f32 v135, v118, v119
    s_waitcnt lgkmcnt(6)
    v_mfma_f32_16x16x32_bf16 v[96:99], a[116:119], a[20:23], v[96:99]
    v_cvt_pk_bf16_f32 v138, v120, v121
    v_cvt_pk_bf16_f32 v139, v122, v123
    v_mfma_f32_16x16x32_bf16 v[100:103], a[116:119], a[44:47], v[100:103]
    ds_read_b128 a[96:99], v10 offset:8192
    ds_read_b128 a[100:103], v10 offset:9216
    v_mfma_f32_16x16x32_bf16 v[104:107], a[116:119], a[68:71], v[104:107]
    ds_read_b128 a[104:107], v10 offset:10240
    ds_read_b128 a[108:111], v10 offset:11264
    v_mfma_f32_16x16x32_bf16 v[32:35], a[0:3], v[128:131], 0
    ds_read_b128 a[112:115], v10 offset:12288
    ds_read_b128 a[116:119], v10 offset:13312
    v_mfma_f32_16x16x32_bf16 v[48:51], a[24:27], v[128:131], 0
    ds_read_b128 a[144:147], v25 offset:0
    ds_read_b128 a[148:151], v25 offset:1024
    v_mfma_f32_16x16x32_bf16 v[64:67], a[48:51], v[128:131], 0
    ds_read_b128 a[152:155], v25 offset:2048
    ds_read_b128 a[156:159], v25 offset:3072
    v_mfma_f32_16x16x32_bf16 v[80:83], a[72:75], v[128:131], 0
    ds_read_b128 a[160:163], v25 offset:4096
    ds_read_b128 a[164:167], v25 offset:5120
    v_mfma_f32_16x16x32_bf16 v[36:39], a[0:3], v[132:135], 0
    v_cvt_pk_bf16_f32 v144, v96, v97
    v_cvt_pk_bf16_f32 v145, v98, v99
    v_mfma_f32_16x16x32_bf16 v[52:55], a[24:27], v[132:135], 0
    v_cvt_pk_bf16_f32 v148, v100, v101
    v_cvt_pk_bf16_f32 v149, v102, v103
    v_mfma_f32_16x16x32_bf16 v[68:71], a[48:51], v[132:135], 0
    v_cvt_pk_bf16_f32 v152, v104, v105
    v_cvt_pk_bf16_f32 v153, v106, v107
    v_mfma_f32_16x16x32_bf16 v[84:87], a[72:75], v[132:135], 0
    s_mov_b32 s50, 0
    s_add_u32 m0, s49, 0
    v_mfma_f32_16x16x32_bf16 v[40:43], a[0:3], v[136:139], 0
    buffer_load_dwordx4 v11, s[28:31], s50 offen offset:0 sc1 lds
    buffer_load_dwordx4 v11, s[28:31], s50 offen offset:1024 sc1 lds
    v_mfma_f32_16x16x32_bf16 v[56:59], a[24:27], v[136:139], 0
    buffer_load_dwordx4 v11, s[28:31], s50 offen offset:2048 sc1 lds
    buffer_load_dwordx4 v11, s[28:31], s50 offen offset:3072 sc1 lds
    v_mfma_f32_16x16x32_bf16 v[72:75], a[48:51], v[136:139], 0
    s_mov_b32 s50, 4096
    s_add_u32 m0, s49, 4096
    v_mfma_f32_16x16x32_bf16 v[88:91], a[72:75], v[136:139], 0
    buffer_load_dwordx4 v11, s[28:31], s50 offen offset:0 sc1 lds
    buffer_load_dwordx4 v11, s[28:31], s50 offen offset:1024 sc1 lds
    s_waitcnt lgkmcnt(15)
    v_mfma_f32_16x16x32_bf16 v[112:115], a[120:123], a[0:3], 0
    s_mov_b32 s50, 24576
    s_add_u32 m0, s49, 24576
    v_mfma_f32_16x16x32_bf16 v[116:119], a[120:123], a[24:27], 0
    buffer_load_dwordx4 v11, s[28:31], s50 offen offset:0 sc1 lds
    buffer_load_dwordx4 v11, s[28:31], s50 offen offset:1024 sc1 lds
    v_mfma_f32_16x16x32_bf16 v[120:123], a[120:123], a[48:51], 0
    ds_read_b128 a[120:123], v10 offset:14336
    buffer_load_dwordx4 v11, s[28:31], s50 offen offset:2048 sc1 lds
    s_waitcnt lgkmcnt(6)
    v_mfma_f32_16x16x32_bf16 v[108:111], a[144:147], a[72:75], 0
    ds_read_b128 a[144:147], v25 offset:24576
    buffer_load_dwordx4 v11, s[28:31], s50 offen offset:3072 sc1 lds
    v_mfma_f32_16x16x32_bf16 v[112:115], a[124:127], a[4:7], v[112:115]
    s_mov_b32 s50, 28672
    s_add_u32 m0, s49, 28672
    v_mfma_f32_16x16x32_bf16 v[116:119], a[124:127], a[28:31], v[116:119]
    buffer_load_dwordx4 v11, s[28:31], s50 offen offset:0 sc1 lds
    buffer_load_dwordx4 v11, s[28:31], s50 offen offset:1024 sc1 lds
    v_mfma_f32_16x16x32_bf16 v[120:123], a[124:127], a[52:55], v[120:123]
    ds_read_b128 a[124:127], v10 offset:15360
    s_mov_b32 s50, 49152
    s_waitcnt lgkmcnt(7)
    v_mfma_f32_16x16x32_bf16 v[108:111], a[148:151], a[76:79], v[108:111]
    ds_read_b128 a[148:151], v25 offset:25600
    s_add_u32 m0, s49, 49152
    v_mfma_f32_16x16x32_bf16 v[112:115], a[128:131], a[8:11], v[112:115]
    buffer_load_dwordx4 v11, s[28:31], s50 offen offset:0 sc1 lds
    buffer_load_dwordx4 v11, s[28:31], s50 offen offset:1024 sc1 lds
    v_mfma_f32_16x16x32_bf16 v[116:119], a[128:131], a[32:35], v[116:119]
    buffer_load_dwordx4 v11, s[28:31], s50 offen offset:2048 sc1 lds
    buffer_load_dwordx4 v11, s[28:31], s50 offen offset:3072 sc1 lds
    v_mfma_f32_16x16x32_bf16 v[120:123], a[128:131], a[56:59], v[120:123]
    ds_read_b128 a[128:131], v10 offset:16384
    s_mov_b32 s50, 53248
    s_waitcnt lgkmcnt(8)
    v_mfma_f32_16x16x32_bf16 v[108:111], a[152:155], a[80:83], v[108:111]
    ds_read_b128 a[152:155], v25 offset:26624
    s_add_u32 m0, s49, 53248
    v_mfma_f32_16x16x32_bf16 v[112:115], a[132:135], a[12:15], v[112:115]
    buffer_load_dwordx4 v11, s[28:31], s50 offen offset:0 sc1 lds
    buffer_load_dwordx4 v11, s[28:31], s50 offen offset:1024 sc1 lds
    v_mfma_f32_16x16x32_bf16 v[116:119], a[132:135], a[36:39], v[116:119]
    v_mfma_f32_16x16x32_bf16 v[120:123], a[132:135], a[60:63], v[120:123]
    ds_read_b128 a[132:135], v10 offset:17408
    s_waitcnt lgkmcnt(9)
    v_mfma_f32_16x16x32_bf16 v[108:111], a[156:159], a[84:87], v[108:111]
    ds_read_b128 a[156:159], v25 offset:27648
    v_mfma_f32_16x16x32_bf16 v[112:115], a[136:139], a[16:19], v[112:115]
    v_mfma_f32_16x16x32_bf16 v[116:119], a[136:139], a[40:43], v[116:119]
    v_mfma_f32_16x16x32_bf16 v[120:123], a[136:139], a[64:67], v[120:123]
    ds_read_b128 a[136:139], v10 offset:18432
    s_waitcnt lgkmcnt(10)
    v_mfma_f32_16x16x32_bf16 v[108:111], a[160:163], a[88:91], v[108:111]
    ds_read_b128 a[160:163], v25 offset:28672
    v_mfma_f32_16x16x32_bf16 v[112:115], a[140:143], a[20:23], v[112:115]
    v_mfma_f32_16x16x32_bf16 v[116:119], a[140:143], a[44:47], v[116:119]
    v_mfma_f32_16x16x32_bf16 v[120:123], a[140:143], a[68:71], v[120:123]
    ds_read_b128 a[140:143], v10 offset:19456
    s_waitcnt lgkmcnt(11)
    v_mfma_f32_16x16x32_bf16 v[108:111], a[164:167], a[92:95], v[108:111]
    ds_read_b128 a[164:167], v25 offset:29696
    v_mfma_f32_16x16x32_bf16 v[96:99], a[96:99], a[0:3], 0
    v_mfma_f32_16x16x32_bf16 v[100:103], a[96:99], a[24:27], 0
    v_mfma_f32_16x16x32_bf16 v[104:107], a[96:99], a[48:51], 0
    v_cvt_pk_bf16_f32 v146, v112, v113
    v_cvt_pk_bf16_f32 v147, v114, v115
    s_waitcnt lgkmcnt(10)
    v_mfma_f32_16x16x32_bf16 v[124:127], a[144:147], a[72:75], 0
    v_cvt_pk_bf16_f32 v150, v116, v117
    v_cvt_pk_bf16_f32 v151, v118, v119
    v_mfma_f32_16x16x32_bf16 v[96:99], a[100:103], a[4:7], v[96:99]
    v_cvt_pk_bf16_f32 v154, v120, v121
    v_cvt_pk_bf16_f32 v155, v122, v123
    v_mfma_f32_16x16x32_bf16 v[100:103], a[100:103], a[28:31], v[100:103]
    v_cvt_pk_bf16_f32 v108, v108, v109
    v_cvt_pk_bf16_f32 v109, v110, v111
    v_mfma_f32_16x16x32_bf16 v[104:107], a[100:103], a[52:55], v[104:107]
    ds_write_b64 v26, v[108:109] offset:0
    ds_read_b128 a[96:99], v10 offset:20480
    s_waitcnt lgkmcnt(10)
    v_mfma_f32_16x16x32_bf16 v[124:127], a[148:151], a[76:79], v[124:127]
    ds_read_b128 a[100:103], v10 offset:21504
    ds_read_b128 a[144:147], v25 offset:49152
    v_mfma_f32_16x16x32_bf16 v[96:99], a[104:107], a[8:11], v[96:99]
    ds_read_b128 a[148:151], v25 offset:50176
    v_mfma_f32_16x16x32_bf16 v[100:103], a[104:107], a[32:35], v[100:103]
    v_mfma_f32_16x16x32_bf16 v[104:107], a[104:107], a[56:59], v[104:107]
    ds_read_b128 a[104:107], v10 offset:22528
    s_waitcnt lgkmcnt(12)
    v_mfma_f32_16x16x32_bf16 v[124:127], a[152:155], a[80:83], v[124:127]
    ds_read_b128 a[152:155], v25 offset:51200
    v_mfma_f32_16x16x32_bf16 v[96:99], a[108:111], a[12:15], v[96:99]
    v_mfma_f32_16x16x32_bf16 v[100:103], a[108:111], a[36:39], v[100:103]
    v_mfma_f32_16x16x32_bf16 v[104:107], a[108:111], a[60:63], v[104:107]
    ds_read_b128 a[108:111], v10 offset:23552
    s_waitcnt lgkmcnt(12)
    v_mfma_f32_16x16x32_bf16 v[124:127], a[156:159], a[84:87], v[124:127]
    ds_read_b128 a[156:159], v25 offset:52224
    v_mfma_f32_16x16x32_bf16 v[96:99], a[112:115], a[16:19], v[96:99]
    v_mfma_f32_16x16x32_bf16 v[100:103], a[112:115], a[40:43], v[100:103]
    v_mfma_f32_16x16x32_bf16 v[104:107], a[112:115], a[64:67], v[104:107]
    ds_read_b128 a[112:115], v10 offset:24576
    s_waitcnt lgkmcnt(12)
    v_mfma_f32_16x16x32_bf16 v[124:127], a[160:163], a[88:91], v[124:127]
    ds_read_b128 a[160:163], v25 offset:53248
    v_mfma_f32_16x16x32_bf16 v[96:99], a[116:119], a[20:23], v[96:99]
    v_mfma_f32_16x16x32_bf16 v[100:103], a[116:119], a[44:47], v[100:103]
    v_mfma_f32_16x16x32_bf16 v[104:107], a[116:119], a[68:71], v[104:107]
    ds_read_b128 a[116:119], v10 offset:25600
    s_waitcnt lgkmcnt(12)
    v_mfma_f32_16x16x32_bf16 v[124:127], a[164:167], a[92:95], v[124:127]
    ds_read_b128 a[164:167], v25 offset:54272
    v_mfma_f32_16x16x32_bf16 v[32:35], a[4:7], v[144:147], v[32:35]
    v_mfma_f32_16x16x32_bf16 v[48:51], a[28:31], v[144:147], v[48:51]
    v_mfma_f32_16x16x32_bf16 v[64:67], a[52:55], v[144:147], v[64:67]
    v_cvt_pk_bf16_f32 v128, v96, v97
    v_cvt_pk_bf16_f32 v129, v98, v99
    v_mfma_f32_16x16x32_bf16 v[80:83], a[76:79], v[144:147], v[80:83]
    v_cvt_pk_bf16_f32 v132, v100, v101
    v_cvt_pk_bf16_f32 v133, v102, v103
    v_mfma_f32_16x16x32_bf16 v[36:39], a[4:7], v[148:151], v[36:39]
    v_cvt_pk_bf16_f32 v136, v104, v105
    v_cvt_pk_bf16_f32 v137, v106, v107
    v_mfma_f32_16x16x32_bf16 v[52:55], a[28:31], v[148:151], v[52:55]
    v_cvt_pk_bf16_f32 v124, v124, v125
    v_cvt_pk_bf16_f32 v125, v126, v127
    v_mfma_f32_16x16x32_bf16 v[68:71], a[52:55], v[148:151], v[68:71]
    ds_write_b64 v26, v[124:125] offset:2048
    v_mfma_f32_16x16x32_bf16 v[84:87], a[76:79], v[148:151], v[84:87]
    v_mfma_f32_16x16x32_bf16 v[40:43], a[4:7], v[152:155], v[40:43]
    v_mfma_f32_16x16x32_bf16 v[56:59], a[28:31], v[152:155], v[56:59]
    v_mfma_f32_16x16x32_bf16 v[72:75], a[52:55], v[152:155], v[72:75]
    v_mfma_f32_16x16x32_bf16 v[88:91], a[76:79], v[152:155], v[88:91]
    v_mfma_f32_16x16x32_bf16 v[112:115], a[120:123], a[0:3], 0
    v_mfma_f32_16x16x32_bf16 v[116:119], a[120:123], a[24:27], 0
    v_mfma_f32_16x16x32_bf16 v[120:123], a[120:123], a[48:51], 0
    ds_read_b128 a[120:123], v10 offset:26624
    s_waitcnt lgkmcnt(11)
    v_mfma_f32_16x16x32_bf16 v[108:111], a[144:147], a[72:75], 0
    v_mfma_f32_16x16x32_bf16 v[112:115], a[124:127], a[4:7], v[112:115]
    v_mfma_f32_16x16x32_bf16 v[116:119], a[124:127], a[28:31], v[116:119]
    v_mfma_f32_16x16x32_bf16 v[120:123], a[124:127], a[52:55], v[120:123]
    ds_read_b128 a[124:127], v10 offset:27648
    s_waitcnt lgkmcnt(11)
    v_mfma_f32_16x16x32_bf16 v[108:111], a[148:151], a[76:79], v[108:111]
    v_mfma_f32_16x16x32_bf16 v[112:115], a[128:131], a[8:11], v[112:115]
    v_mfma_f32_16x16x32_bf16 v[116:119], a[128:131], a[32:35], v[116:119]
    v_mfma_f32_16x16x32_bf16 v[120:123], a[128:131], a[56:59], v[120:123]
    ds_read_b128 a[128:131], v10 offset:28672
    s_waitcnt lgkmcnt(10)
    v_mfma_f32_16x16x32_bf16 v[108:111], a[152:155], a[80:83], v[108:111]
    v_mfma_f32_16x16x32_bf16 v[112:115], a[132:135], a[12:15], v[112:115]
    v_mfma_f32_16x16x32_bf16 v[116:119], a[132:135], a[36:39], v[116:119]
    v_mfma_f32_16x16x32_bf16 v[120:123], a[132:135], a[60:63], v[120:123]
    ds_read_b128 a[132:135], v10 offset:29696
    s_waitcnt lgkmcnt(9)
    v_mfma_f32_16x16x32_bf16 v[108:111], a[156:159], a[84:87], v[108:111]
    v_mfma_f32_16x16x32_bf16 v[112:115], a[136:139], a[16:19], v[112:115]
    v_mfma_f32_16x16x32_bf16 v[116:119], a[136:139], a[40:43], v[116:119]
    v_mfma_f32_16x16x32_bf16 v[120:123], a[136:139], a[64:67], v[120:123]
    ds_read_b128 a[136:139], v10 offset:30720
    s_waitcnt lgkmcnt(8)
    v_mfma_f32_16x16x32_bf16 v[108:111], a[160:163], a[88:91], v[108:111]
    v_mfma_f32_16x16x32_bf16 v[112:115], a[140:143], a[20:23], v[112:115]
    v_mfma_f32_16x16x32_bf16 v[116:119], a[140:143], a[44:47], v[116:119]
    v_mfma_f32_16x16x32_bf16 v[120:123], a[140:143], a[68:71], v[120:123]
    ds_read_b128 a[140:143], v10 offset:31744
    s_waitcnt lgkmcnt(7)
    v_mfma_f32_16x16x32_bf16 v[108:111], a[164:167], a[92:95], v[108:111]
    v_mfma_f32_16x16x32_bf16 v[96:99], a[96:99], a[0:3], 0
    v_mfma_f32_16x16x32_bf16 v[100:103], a[96:99], a[24:27], 0
    v_mfma_f32_16x16x32_bf16 v[104:107], a[96:99], a[48:51], 0
    ds_read_b128 a[96:99], v10 offset:32768
    v_cvt_pk_bf16_f32 v130, v112, v113
    v_mfma_f32_16x16x32_bf16 v[96:99], a[100:103], a[4:7], v[96:99]
    v_cvt_pk_bf16_f32 v131, v114, v115
    v_cvt_pk_bf16_f32 v134, v116, v117
    v_mfma_f32_16x16x32_bf16 v[100:103], a[100:103], a[28:31], v[100:103]
    v_cvt_pk_bf16_f32 v135, v118, v119
    v_cvt_pk_bf16_f32 v138, v120, v121
    v_mfma_f32_16x16x32_bf16 v[104:107], a[100:103], a[52:55], v[104:107]
    v_cvt_pk_bf16_f32 v139, v122, v123
    v_cvt_pk_bf16_f32 v108, v108, v109
    v_mfma_f32_16x16x32_bf16 v[96:99], a[104:107], a[8:11], v[96:99]
    v_cvt_pk_bf16_f32 v109, v110, v111
    ds_read_b128 a[100:103], v10 offset:33792
    v_mfma_f32_16x16x32_bf16 v[100:103], a[104:107], a[32:35], v[100:103]
    ds_write_b64 v26, v[108:109] offset:4096
    v_mfma_f32_16x16x32_bf16 v[104:107], a[104:107], a[56:59], v[104:107]
    ds_read_b128 a[104:107], v10 offset:34816
    v_mfma_f32_16x16x32_bf16 v[96:99], a[108:111], a[12:15], v[96:99]
    v_mfma_f32_16x16x32_bf16 v[100:103], a[108:111], a[36:39], v[100:103]
    v_mfma_f32_16x16x32_bf16 v[104:107], a[108:111], a[60:63], v[104:107]
    ds_read_b128 a[108:111], v10 offset:35840
    v_mfma_f32_16x16x32_bf16 v[96:99], a[112:115], a[16:19], v[96:99]
    v_mfma_f32_16x16x32_bf16 v[100:103], a[112:115], a[40:43], v[100:103]
    v_mfma_f32_16x16x32_bf16 v[104:107], a[112:115], a[64:67], v[104:107]
    ds_read_b128 a[112:115], v10 offset:36864
    v_mfma_f32_16x16x32_bf16 v[96:99], a[116:119], a[20:23], v[96:99]
    v_mfma_f32_16x16x32_bf16 v[100:103], a[116:119], a[44:47], v[100:103]
    v_mfma_f32_16x16x32_bf16 v[104:107], a[116:119], a[68:71], v[104:107]
    ds_read_b128 a[116:119], v10 offset:37888
    v_mfma_f32_16x16x32_bf16 v[32:35], a[8:11], v[128:131], v[32:35]
    v_mfma_f32_16x16x32_bf16 v[48:51], a[32:35], v[128:131], v[48:51]
    v_mfma_f32_16x16x32_bf16 v[64:67], a[56:59], v[128:131], v[64:67]
    v_mfma_f32_16x16x32_bf16 v[80:83], a[80:83], v[128:131], v[80:83]
    v_mfma_f32_16x16x32_bf16 v[36:39], a[8:11], v[132:135], v[36:39]
    v_mfma_f32_16x16x32_bf16 v[52:55], a[32:35], v[132:135], v[52:55]
    v_mfma_f32_16x16x32_bf16 v[68:71], a[56:59], v[132:135], v[68:71]
    v_mfma_f32_16x16x32_bf16 v[84:87], a[80:83], v[132:135], v[84:87]
    v_mfma_f32_16x16x32_bf16 v[40:43], a[8:11], v[136:139], v[40:43]
    v_mfma_f32_16x16x32_bf16 v[56:59], a[32:35], v[136:139], v[56:59]
    v_mfma_f32_16x16x32_bf16 v[72:75], a[56:59], v[136:139], v[72:75]
    v_mfma_f32_16x16x32_bf16 v[88:91], a[80:83], v[136:139], v[88:91]
    s_waitcnt lgkmcnt(12)
    v_mfma_f32_16x16x32_bf16 v[112:115], a[120:123], a[0:3], 0
    v_mfma_f32_16x16x32_bf16 v[116:119], a[120:123], a[24:27], 0
    v_mfma_f32_16x16x32_bf16 v[120:123], a[120:123], a[48:51], 0
    s_waitcnt lgkmcnt(11)
    v_mfma_f32_16x16x32_bf16 v[112:115], a[124:127], a[4:7], v[112:115]
    v_mfma_f32_16x16x32_bf16 v[116:119], a[124:127], a[28:31], v[116:119]
    v_mfma_f32_16x16x32_bf16 v[120:123], a[124:127], a[52:55], v[120:123]
    s_waitcnt lgkmcnt(10)
    v_mfma_f32_16x16x32_bf16 v[112:115], a[128:131], a[8:11], v[112:115]
    v_mfma_f32_16x16x32_bf16 v[116:119], a[128:131], a[32:35], v[116:119]
    v_mfma_f32_16x16x32_bf16 v[120:123], a[128:131], a[56:59], v[120:123]
    s_waitcnt lgkmcnt(9)
    v_mfma_f32_16x16x32_bf16 v[112:115], a[132:135], a[12:15], v[112:115]
    s_waitcnt vmcnt(0) lgkmcnt(0)
    s_barrier
    v_mfma_f32_16x16x32_bf16 v[116:119], a[132:135], a[36:39], v[116:119]
    ds_read2st64_b64 a[168:171], v27 offset0:0 offset1:1
    ds_read2st64_b64 a[172:175], v27 offset0:2 offset1:3
    v_mfma_f32_16x16x32_bf16 v[120:123], a[132:135], a[60:63], v[120:123]
    ds_read2st64_b64 a[176:179], v27 offset0:4 offset1:5
    ds_read2st64_b64 a[180:183], v27 offset0:6 offset1:7
    v_mfma_f32_16x16x32_bf16 v[112:115], a[136:139], a[16:19], v[112:115]
    ds_read2st64_b64 a[184:187], v27 offset0:8 offset1:9
    ds_read2st64_b64 a[188:191], v27 offset0:10 offset1:11
    v_mfma_f32_16x16x32_bf16 v[116:119], a[136:139], a[40:43], v[116:119]
    v_add_u32 v26, 81920, v26
    v_add_u32 v27, 81920, v27
    v_mfma_f32_16x16x32_bf16 v[120:123], a[136:139], a[64:67], v[120:123]
    v_cvt_pk_bf16_f32 v144, v96, v97
    v_cvt_pk_bf16_f32 v145, v98, v99
    v_mfma_f32_16x16x32_bf16 v[112:115], a[140:143], a[20:23], v[112:115]
    v_cvt_pk_bf16_f32 v148, v100, v101
    v_cvt_pk_bf16_f32 v149, v102, v103
    v_mfma_f32_16x16x32_bf16 v[116:119], a[140:143], a[44:47], v[116:119]
    v_cvt_pk_bf16_f32 v152, v104, v105
    v_cvt_pk_bf16_f32 v153, v106, v107
    v_mfma_f32_16x16x32_bf16 v[120:123], a[140:143], a[68:71], v[120:123]
    ds_read_b128 a[120:123], v10 offset:38912
    ds_read_b128 a[124:127], v10 offset:39936
    ds_read_b128 a[128:131], v10 offset:40960
    ds_read_b128 a[132:135], v10 offset:41984
    ds_read_b128 a[136:139], v10 offset:43008
    ds_read_b128 a[140:143], v10 offset:44032
    ds_read_b128 a[144:147], v11 offset:0
    ds_read_b128 a[148:151], v11 offset:1024
    ds_read_b128 a[152:155], v11 offset:2048
    ds_read_b128 a[156:159], v11 offset:3072
    ds_read_b128 a[160:163], v11 offset:4096
    ds_read_b128 a[164:167], v11 offset:5120
    s_waitcnt lgkmcnt(15)
    v_mfma_f32_16x16x32_bf16 v[44:47], a[0:3], a[168:171], 0
    v_cvt_pk_bf16_f32 v146, v112, v113
    v_cvt_pk_bf16_f32 v147, v114, v115
    v_mfma_f32_16x16x32_bf16 v[60:63], a[24:27], a[168:171], 0
    v_cvt_pk_bf16_f32 v150, v116, v117
    v_cvt_pk_bf16_f32 v151, v118, v119
    v_mfma_f32_16x16x32_bf16 v[76:79], a[48:51], a[168:171], 0
    v_cvt_pk_bf16_f32 v154, v120, v121
    v_cvt_pk_bf16_f32 v155, v122, v123
    v_mfma_f32_16x16x32_bf16 v[92:95], a[72:75], a[168:171], 0
    v_mfma_f32_16x16x32_bf16 v[44:47], a[4:7], a[172:175], v[44:47]
    v_mfma_f32_16x16x32_bf16 v[60:63], a[28:31], a[172:175], v[60:63]
    v_mfma_f32_16x16x32_bf16 v[76:79], a[52:55], a[172:175], v[76:79]
    v_mfma_f32_16x16x32_bf16 v[92:95], a[76:79], a[172:175], v[92:95]
    v_mfma_f32_16x16x32_bf16 v[44:47], a[8:11], a[176:179], v[44:47]
    v_mfma_f32_16x16x32_bf16 v[60:63], a[32:35], a[176:179], v[60:63]
    v_mfma_f32_16x16x32_bf16 v[76:79], a[56:59], a[176:179], v[76:79]
    v_mfma_f32_16x16x32_bf16 v[92:95], a[80:83], a[176:179], v[92:95]
    s_waitcnt lgkmcnt(14)
    v_mfma_f32_16x16x32_bf16 v[44:47], a[12:15], a[180:183], v[44:47]
    v_mfma_f32_16x16x32_bf16 v[60:63], a[36:39], a[180:183], v[60:63]
    v_mfma_f32_16x16x32_bf16 v[76:79], a[60:63], a[180:183], v[76:79]
    v_mfma_f32_16x16x32_bf16 v[92:95], a[84:87], a[180:183], v[92:95]
    s_waitcnt lgkmcnt(13)
    v_mfma_f32_16x16x32_bf16 v[44:47], a[16:19], a[184:187], v[44:47]
    v_mfma_f32_16x16x32_bf16 v[60:63], a[40:43], a[184:187], v[60:63]
    v_mfma_f32_16x16x32_bf16 v[76:79], a[64:67], a[184:187], v[76:79]
    v_mfma_f32_16x16x32_bf16 v[92:95], a[88:91], a[184:187], v[92:95]
    s_waitcnt lgkmcnt(12)
    v_mfma_f32_16x16x32_bf16 v[44:47], a[20:23], a[188:191], v[44:47]
    v_mfma_f32_16x16x32_bf16 v[60:63], a[44:47], a[188:191], v[60:63]
    v_mfma_f32_16x16x32_bf16 v[76:79], a[68:71], a[188:191], v[76:79]
    v_mfma_f32_16x16x32_bf16 v[92:95], a[92:95], a[188:191], v[92:95]
    v_mfma_f32_16x16x32_bf16 v[96:99], a[96:99], a[0:3], 0
    v_mfma_f32_16x16x32_bf16 v[100:103], a[96:99], a[24:27], 0
    v_mfma_f32_16x16x32_bf16 v[104:107], a[96:99], a[48:51], 0
    ds_read_b128 a[96:99], v10 offset:45056
    s_waitcnt lgkmcnt(6)
    v_mfma_f32_16x16x32_bf16 v[108:111], a[72:75], a[144:147], 0
    ds_read_b128 a[144:147], v11 offset:24576
    v_max3_f32 v20, v44, v45, v46
    v_mfma_f32_16x16x32_bf16 v[96:99], a[100:103], a[4:7], v[96:99]
    v_cndmask_b32 v92, v15, v92, s[44:45]
    v_max3_f32 v21, v47, v60, v61
    v_mfma_f32_16x16x32_bf16 v[100:103], a[100:103], a[28:31], v[100:103]
    v_max3_f32 v20, v20, v62, v63
    v_max3_f32 v21, v21, v76, v77
    v_mfma_f32_16x16x32_bf16 v[104:107], a[100:103], a[52:55], v[104:107]
    ds_read_b128 a[100:103], v10 offset:46080
    v_max3_f32 v20, v20, v78, v79
    s_waitcnt lgkmcnt(7)
    v_mfma_f32_16x16x32_bf16 v[108:111], a[76:79], a[148:151], v[108:111]
    ds_read_b128 a[148:151], v11 offset:25600
    v_max3_f32 v20, v20, v21, v92
    v_mfma_f32_16x16x32_bf16 v[96:99], a[104:107], a[8:11], v[96:99]
    v_mov_b32 v21, v20
    v_mfma_f32_16x16x32_bf16 v[100:103], a[104:107], a[32:35], v[100:103]
    v_mfma_f32_16x16x32_bf16 v[104:107], a[104:107], a[56:59], v[104:107]
    ds_read_b128 a[104:107], v10 offset:47104
    v_permlane32_swap_b32 v20, v21
    s_waitcnt lgkmcnt(8)
    v_mfma_f32_16x16x32_bf16 v[108:111], a[80:83], a[152:155], v[108:111]
    ds_read_b128 a[152:155], v11 offset:26624
    v_max_f32 v20, v20, v21
    v_mfma_f32_16x16x32_bf16 v[96:99], a[108:111], a[12:15], v[96:99]
    v_mov_b32 v21, v20
    v_mfma_f32_16x16x32_bf16 v[100:103], a[108:111], a[36:39], v[100:103]
    v_mfma_f32_16x16x32_bf16 v[104:107], a[108:111], a[60:63], v[104:107]
    ds_read_b128 a[108:111], v10 offset:48128
    v_permlane16_swap_b32 v20, v21
    s_waitcnt lgkmcnt(9)
    v_mfma_f32_16x16x32_bf16 v[108:111], a[84:87], a[156:159], v[108:111]
    ds_read_b128 a[156:159], v11 offset:27648
    v_max_f32 v20, v20, v21
    v_mfma_f32_16x16x32_bf16 v[96:99], a[112:115], a[16:19], v[96:99]
    v_mul_f32 v20, s42, v20
    v_mfma_f32_16x16x32_bf16 v[100:103], a[112:115], a[40:43], v[100:103]
    v_fma_f32 v44, v44, s42, -v20
    v_fma_f32 v45, v45, s42, -v20
    v_mfma_f32_16x16x32_bf16 v[104:107], a[112:115], a[64:67], v[104:107]
    ds_read_b128 a[112:115], v10 offset:49152
    v_fma_f32 v46, v46, s42, -v20
    s_waitcnt lgkmcnt(10)
    v_mfma_f32_16x16x32_bf16 v[108:111], a[88:91], a[160:163], v[108:111]
    ds_read_b128 a[160:163], v11 offset:28672
    v_fma_f32 v47, v47, s42, -v20
    v_mfma_f32_16x16x32_bf16 v[96:99], a[116:119], a[20:23], v[96:99]
    v_exp_f32 v44, v44
    v_mfma_f32_16x16x32_bf16 v[100:103], a[116:119], a[44:47], v[100:103]
    v_exp_f32 v45, v45
    v_mfma_f32_16x16x32_bf16 v[104:107], a[116:119], a[68:71], v[104:107]
    ds_read_b128 a[116:119], v10 offset:50176
    v_add_f32 v22, v44, v45
    s_waitcnt lgkmcnt(11)
    v_mfma_f32_16x16x32_bf16 v[108:111], a[92:95], a[164:167], v[108:111]
    ds_read_b128 a[164:167], v11 offset:29696
    v_cvt_pk_bf16_f32 v128, v96, v97
    v_mfma_f32_16x16x32_bf16 v[32:35], a[12:15], v[144:147], v[32:35]
    v_cvt_pk_bf16_f32 v129, v98, v99
    v_cvt_pk_bf16_f32 v132, v100, v101
    v_mfma_f32_16x16x32_bf16 v[48:51], a[36:39], v[144:147], v[48:51]
    v_cvt_pk_bf16_f32 v133, v102, v103
    v_cvt_pk_bf16_f32 v136, v104, v105
    v_mfma_f32_16x16x32_bf16 v[64:67], a[60:63], v[144:147], v[64:67]
    v_cvt_pk_bf16_f32 v137, v106, v107
    v_cvt_pk_bf16_f32 v108, v108, v109
    v_mfma_f32_16x16x32_bf16 v[80:83], a[84:87], v[144:147], v[80:83]
    v_cvt_pk_bf16_f32 v109, v110, v111
    v_fma_f32 v60, v60, s42, -v20
    v_mfma_f32_16x16x32_bf16 v[36:39], a[12:15], v[148:151], v[36:39]
    ds_write_b64 v26, v[108:109] offset:0
    v_fma_f32 v61, v61, s42, -v20
    v_mfma_f32_16x16x32_bf16 v[52:55], a[36:39], v[148:151], v[52:55]
    v_exp_f32 v46, v46
    v_mfma_f32_16x16x32_bf16 v[68:71], a[60:63], v[148:151], v[68:71]
    v_exp_f32 v47, v47
    v_mfma_f32_16x16x32_bf16 v[84:87], a[84:87], v[148:151], v[84:87]
    v_exp_f32 v60, v60
    v_mfma_f32_16x16x32_bf16 v[40:43], a[12:15], v[152:155], v[40:43]
    v_add_f32 v23, v46, v47
    v_fma_f32 v62, v62, s42, -v20
    v_mfma_f32_16x16x32_bf16 v[56:59], a[36:39], v[152:155], v[56:59]
    v_exp_f32 v61, v61
    v_mfma_f32_16x16x32_bf16 v[72:75], a[60:63], v[152:155], v[72:75]
    v_add_f32 v23, v23, v60
    v_add_f32 v22, v22, v61
    v_mfma_f32_16x16x32_bf16 v[88:91], a[84:87], v[152:155], v[88:91]
    v_exp_f32 v62, v62
    v_mfma_f32_16x16x32_bf16 v[112:115], a[120:123], a[0:3], 0
    v_fma_f32 v63, v63, s42, -v20
    v_add_f32 v23, v23, v62
    v_mfma_f32_16x16x32_bf16 v[116:119], a[120:123], a[24:27], 0
    v_exp_f32 v63, v63
    v_mfma_f32_16x16x32_bf16 v[120:123], a[120:123], a[48:51], 0
    ds_read_b128 a[120:123], v10 offset:51200
    v_fma_f32 v76, v76, s42, -v20
    s_waitcnt lgkmcnt(12)
    v_mfma_f32_16x16x32_bf16 v[124:127], a[72:75], a[144:147], 0
    ds_read_b128 a[144:147], v11 offset:49152
    v_add_f32 v22, v22, v63
    v_mfma_f32_16x16x32_bf16 v[112:115], a[124:127], a[4:7], v[112:115]
    v_exp_f32 v76, v76
    v_mfma_f32_16x16x32_bf16 v[116:119], a[124:127], a[28:31], v[116:119]
    v_fma_f32 v77, v77, s42, -v20
    v_add_f32 v23, v23, v76
    v_mfma_f32_16x16x32_bf16 v[120:123], a[124:127], a[52:55], v[120:123]
    ds_read_b128 a[124:127], v10 offset:52224
    v_fma_f32 v78, v78, s42, -v20
    s_waitcnt lgkmcnt(12)
    v_mfma_f32_16x16x32_bf16 v[124:127], a[76:79], a[148:151], v[124:127]
    ds_read_b128 a[148:151], v11 offset:50176
    v_fma_f32 v79, v79, s42, -v20
    v_mfma_f32_16x16x32_bf16 v[112:115], a[128:131], a[8:11], v[112:115]
    v_exp_f32 v77, v77
    v_mfma_f32_16x16x32_bf16 v[116:119], a[128:131], a[32:35], v[116:119]
    v_exp_f32 v78, v78
    v_mfma_f32_16x16x32_bf16 v[120:123], a[128:131], a[56:59], v[120:123]
    ds_read_b128 a[128:131], v10 offset:53248
    v_add_f32 v22, v22, v77
    s_waitcnt lgkmcnt(12)
    v_mfma_f32_16x16x32_bf16 v[124:127], a[80:83], a[152:155], v[124:127]
    ds_read_b128 a[152:155], v11 offset:51200
    v_add_f32 v23, v23, v78
    v_mfma_f32_16x16x32_bf16 v[112:115], a[132:135], a[12:15], v[112:115]
    v_exp_f32 v79, v79
    v_mfma_f32_16x16x32_bf16 v[116:119], a[132:135], a[36:39], v[116:119]
    v_fma_f32 v92, v92, s42, -v20
    v_add_f32 v22, v22, v79
    v_mfma_f32_16x16x32_bf16 v[120:123], a[132:135], a[60:63], v[120:123]
    ds_read_b128 a[132:135], v10 offset:54272
    s_waitcnt lgkmcnt(12)
    v_mfma_f32_16x16x32_bf16 v[124:127], a[84:87], a[156:159], v[124:127]
    ds_read_b128 a[156:159], v11 offset:52224
    v_mfma_f32_16x16x32_bf16 v[112:115], a[136:139], a[16:19], v[112:115]
    v_exp_f32 v92, v92
    v_mfma_f32_16x16x32_bf16 v[116:119], a[136:139], a[40:43], v[116:119]
    v_add_f32 v23, v23, v92
    v_mfma_f32_16x16x32_bf16 v[120:123], a[136:139], a[64:67], v[120:123]
    ds_read_b128 a[136:139], v10 offset:55296
    v_add_f32 v22, v22, v23
    s_waitcnt lgkmcnt(12)
    v_mfma_f32_16x16x32_bf16 v[124:127], a[88:91], a[160:163], v[124:127]
    ds_read_b128 a[160:163], v11 offset:53248
    v_mov_b32 v23, v22
    v_mfma_f32_16x16x32_bf16 v[112:115], a[140:143], a[20:23], v[112:115]
    v_mfma_f32_16x16x32_bf16 v[116:119], a[140:143], a[44:47], v[116:119]
    v_permlane32_swap_b32 v22, v23
    v_mfma_f32_16x16x32_bf16 v[120:123], a[140:143], a[68:71], v[120:123]
    ds_read_b128 a[140:143], v10 offset:56320
    v_add_f32 v22, v22, v23
    s_waitcnt lgkmcnt(12)
    v_mfma_f32_16x16x32_bf16 v[124:127], a[92:95], a[164:167], v[124:127]
    ds_read_b128 a[164:167], v11 offset:54272
    v_mov_b32 v23, v22
    v_mfma_f32_16x16x32_bf16 v[96:99], a[96:99], a[0:3], 0
    v_cvt_pk_bf16_f32 v130, v112, v113
    v_cvt_pk_bf16_f32 v131, v114, v115
    v_mfma_f32_16x16x32_bf16 v[100:103], a[96:99], a[24:27], 0
    v_cvt_pk_bf16_f32 v134, v116, v117
    v_cvt_pk_bf16_f32 v135, v118, v119
    v_mfma_f32_16x16x32_bf16 v[104:107], a[96:99], a[48:51], 0
    v_cvt_pk_bf16_f32 v138, v120, v121
    v_cvt_pk_bf16_f32 v139, v122, v123
    s_waitcnt lgkmcnt(10)
    v_mfma_f32_16x16x32_bf16 v[108:111], a[72:75], a[144:147], 0
    v_cvt_pk_bf16_f32 v124, v124, v125
    v_cvt_pk_bf16_f32 v125, v126, v127
    v_mfma_f32_16x16x32_bf16 v[96:99], a[100:103], a[4:7], v[96:99]
    ds_write_b64 v26, v[124:125] offset:2048
    ds_read_b128 a[96:99], v8 offset:0
    v_mfma_f32_16x16x32_bf16 v[100:103], a[100:103], a[28:31], v[100:103]
    v_permlane16_swap_b32 v22, v23
    v_mfma_f32_16x16x32_bf16 v[104:107], a[100:103], a[52:55], v[104:107]
    ds_read_b128 a[100:103], v8 offset:1024
    v_add_f32 v22, v22, v23
    s_waitcnt lgkmcnt(11)
    v_mfma_f32_16x16x32_bf16 v[108:111], a[76:79], a[148:151], v[108:111]
    v_rcp_f32 v22, v22
    v_mfma_f32_16x16x32_bf16 v[96:99], a[104:107], a[8:11], v[96:99]
    v_mul_f32 v44, v44, v22
    v_mul_f32 v45, v45, v22
    v_mfma_f32_16x16x32_bf16 v[100:103], a[104:107], a[32:35], v[100:103]
    v_cvt_pk_bf16_f32 v184, v44, v45
    v_mul_f32 v46, v46, v22
    v_mfma_f32_16x16x32_bf16 v[104:107], a[104:107], a[56:59], v[104:107]
    ds_read_b128 a[104:107], v8 offset:2048
    v_mul_f32 v47, v47, v22
    s_waitcnt lgkmcnt(10)
    v_mfma_f32_16x16x32_bf16 v[108:111], a[80:83], a[152:155], v[108:111]
    v_cvt_pk_bf16_f32 v185, v46, v47
    v_mul_f32 v60, v60, v22
    v_mfma_f32_16x16x32_bf16 v[96:99], a[108:111], a[12:15], v[96:99]
    v_mul_f32 v61, v61, v22
    v_mul_f32 v62, v62, v22
    v_mfma_f32_16x16x32_bf16 v[100:103], a[108:111], a[36:39], v[100:103]
    v_cvt_pk_bf16_f32 v186, v60, v61
    v_mul_f32 v63, v63, v22
    v_mfma_f32_16x16x32_bf16 v[104:107], a[108:111], a[60:63], v[104:107]
    ds_read_b128 a[108:111], v8 offset:3072
    v_cvt_pk_bf16_f32 v187, v62, v63
    s_waitcnt lgkmcnt(9)
    v_mfma_f32_16x16x32_bf16 v[108:111], a[84:87], a[156:159], v[108:111]
    v_mul_f32 v76, v76, v22
    v_mul_f32 v77, v77, v22
    v_mfma_f32_16x16x32_bf16 v[96:99], a[112:115], a[16:19], v[96:99]
    v_cvt_pk_bf16_f32 v188, v76, v77
    v_mul_f32 v78, v78, v22
    v_mfma_f32_16x16x32_bf16 v[100:103], a[112:115], a[40:43], v[100:103]
    v_mul_f32 v79, v79, v22
    v_mul_f32 v92, v92, v22
    v_mfma_f32_16x16x32_bf16 v[104:107], a[112:115], a[64:67], v[104:107]
    ds_read_b128 a[112:115], v8 offset:4096
    v_cvt_pk_bf16_f32 v189, v78, v79
    s_waitcnt lgkmcnt(8)
    v_mfma_f32_16x16x32_bf16 v[108:111], a[88:91], a[160:163], v[108:111]
    v_cvt_pk_bf16_f32 v190, v92, 0
    v_mov_b32 v191, 0
    v_mfma_f32_16x16x32_bf16 v[96:99], a[116:119], a[20:23], v[96:99]
    v_mfma_f32_16x16x32_bf16 v[100:103], a[116:119], a[44:47], v[100:103]
    v_mfma_f32_16x16x32_bf16 v[104:107], a[116:119], a[68:71], v[104:107]
    ds_read_b128 a[116:119], v8 offset:5120
    s_waitcnt lgkmcnt(7)
    v_mfma_f32_16x16x32_bf16 v[108:111], a[92:95], a[164:167], v[108:111]
    v_mfma_f32_16x16x32_bf16 v[32:35], a[16:19], v[128:131], v[32:35]
    v_mfma_f32_16x16x32_bf16 v[48:51], a[40:43], v[128:131], v[48:51]
    v_mfma_f32_16x16x32_bf16 v[64:67], a[64:67], v[128:131], v[64:67]
    v_mfma_f32_16x16x32_bf16 v[80:83], a[88:91], v[128:131], v[80:83]
    v_mfma_f32_16x16x32_bf16 v[36:39], a[16:19], v[132:135], v[36:39]
    v_mfma_f32_16x16x32_bf16 v[52:55], a[40:43], v[132:135], v[52:55]
    v_mfma_f32_16x16x32_bf16 v[68:71], a[64:67], v[132:135], v[68:71]
    v_mfma_f32_16x16x32_bf16 v[84:87], a[88:91], v[132:135], v[84:87]
    v_cvt_pk_bf16_f32 v108, v108, v109
    v_cvt_pk_bf16_f32 v109, v110, v111
    v_mfma_f32_16x16x32_bf16 v[40:43], a[16:19], v[136:139], v[40:43]
    ds_write_b64 v26, v[108:109] offset:4096
    v_mfma_f32_16x16x32_bf16 v[56:59], a[40:43], v[136:139], v[56:59]
    v_mfma_f32_16x16x32_bf16 v[72:75], a[64:67], v[136:139], v[72:75]
    v_mfma_f32_16x16x32_bf16 v[88:91], a[88:91], v[136:139], v[88:91]
    v_mfma_f32_16x16x32_bf16 v[112:115], a[120:123], a[0:3], 0
    v_mfma_f32_16x16x32_bf16 v[116:119], a[120:123], a[24:27], 0
    v_mfma_f32_16x16x32_bf16 v[120:123], a[120:123], a[48:51], 0
    v_mfma_f32_16x16x32_bf16 v[112:115], a[124:127], a[4:7], v[112:115]
    v_mfma_f32_16x16x32_bf16 v[116:119], a[124:127], a[28:31], v[116:119]
    v_mfma_f32_16x16x32_bf16 v[120:123], a[124:127], a[52:55], v[120:123]
    v_mfma_f32_16x16x32_bf16 v[112:115], a[128:131], a[8:11], v[112:115]
    v_mfma_f32_16x16x32_bf16 v[116:119], a[128:131], a[32:35], v[116:119]
    v_mfma_f32_16x16x32_bf16 v[120:123], a[128:131], a[56:59], v[120:123]
    v_mfma_f32_16x16x32_bf16 v[112:115], a[132:135], a[12:15], v[112:115]
    s_waitcnt lgkmcnt(0)
    s_barrier
    v_mfma_f32_16x16x32_bf16 v[116:119], a[132:135], a[36:39], v[116:119]
    v_cvt_pk_bf16_f32 v144, v96, v97
    v_cvt_pk_bf16_f32 v145, v98, v99
    v_mfma_f32_16x16x32_bf16 v[120:123], a[132:135], a[60:63], v[120:123]
    v_cvt_pk_bf16_f32 v148, v100, v101
    v_cvt_pk_bf16_f32 v149, v102, v103
    v_mfma_f32_16x16x32_bf16 v[112:115], a[136:139], a[16:19], v[112:115]
    v_cvt_pk_bf16_f32 v152, v104, v105
    v_cvt_pk_bf16_f32 v153, v106, v107
    v_mfma_f32_16x16x32_bf16 v[116:119], a[136:139], a[40:43], v[116:119]
    ds_read_b128 a[120:123], v8 offset:6144
    ds_read_b128 a[124:127], v8 offset:7168
    v_mfma_f32_16x16x32_bf16 v[120:123], a[136:139], a[64:67], v[120:123]
    ds_read_b128 a[128:131], v8 offset:8192
    ds_read_b128 a[132:135], v8 offset:9216
    v_mfma_f32_16x16x32_bf16 v[112:115], a[140:143], a[20:23], v[112:115]
    ds_read_b128 a[136:139], v8 offset:10240
    ds_read_b64 v[134:135], v27 offset:4096
    v_mfma_f32_16x16x32_bf16 v[116:119], a[140:143], a[44:47], v[116:119]
    ds_read_b64 v[142:143], v27 offset:4608
    ds_read_b64 v[158:159], v27 offset:5632
    v_mfma_f32_16x16x32_bf16 v[120:123], a[140:143], a[68:71], v[120:123]
    ds_read_b128 a[140:143], v8 offset:11264
    ds_read_b64 v[198:199], v27 offset:0
    v_mfma_f32_16x16x32_bf16 v[96:99], a[0:3], a[96:99], 0
    v_cvt_pk_bf16_f32 v146, v112, v113
    v_cvt_pk_bf16_f32 v147, v114, v115
    v_mfma_f32_16x16x32_bf16 v[100:103], a[24:27], a[96:99], 0
    v_cvt_pk_bf16_f32 v150, v116, v117
    v_cvt_pk_bf16_f32 v151, v118, v119
    v_mfma_f32_16x16x32_bf16 v[104:107], a[48:51], a[96:99], 0
    v_cvt_pk_bf16_f32 v154, v120, v121
    v_cvt_pk_bf16_f32 v155, v122, v123
    v_mfma_f32_16x16x32_bf16 v[96:99], a[4:7], a[100:103], v[96:99]
    ds_read_b128 a[96:99], v8 offset:12288
    ds_read_b64 v[206:207], v27 offset:512
    v_mfma_f32_16x16x32_bf16 v[100:103], a[28:31], a[100:103], v[100:103]
    ds_read_b64 v[214:215], v27 offset:1024
    ds_read_b64 v[222:223], v27 offset:1536
    v_mfma_f32_16x16x32_bf16 v[104:107], a[52:55], a[100:103], v[104:107]
    ds_read_b128 a[100:103], v8 offset:13312
    ds_read_b64 v[230:231], v27 offset:2048
    v_mfma_f32_16x16x32_bf16 v[96:99], a[8:11], a[104:107], v[96:99]
    ds_read_b64 v[238:239], v27 offset:2560
    ds_read_b64 v[246:247], v27 offset:3072
    v_mfma_f32_16x16x32_bf16 v[100:103], a[32:35], a[104:107], v[100:103]
    ds_read_b64 v[254:255], v27 offset:3584
    v_mfma_f32_16x16x32_bf16 v[104:107], a[56:59], a[104:107], v[104:107]
    ds_read_b128 a[104:107], v8 offset:14336
    v_mfma_f32_16x16x32_bf16 v[96:99], a[12:15], a[108:111], v[96:99]
    v_mfma_f32_16x16x32_bf16 v[100:103], a[36:39], a[108:111], v[100:103]
    v_mfma_f32_16x16x32_bf16 v[104:107], a[60:63], a[108:111], v[104:107]
    ds_read_b128 a[108:111], v8 offset:15360
    v_mfma_f32_16x16x32_bf16 v[96:99], a[16:19], a[112:115], v[96:99]
    v_mfma_f32_16x16x32_bf16 v[100:103], a[40:43], a[112:115], v[100:103]
    v_mfma_f32_16x16x32_bf16 v[104:107], a[64:67], a[112:115], v[104:107]
    ds_read_b128 a[112:115], v8 offset:16384
    v_mfma_f32_16x16x32_bf16 v[96:99], a[20:23], a[116:119], v[96:99]
    v_mfma_f32_16x16x32_bf16 v[100:103], a[44:47], a[116:119], v[100:103]
    v_mfma_f32_16x16x32_bf16 v[104:107], a[68:71], a[116:119], v[104:107]
    ds_read_b128 a[116:119], v8 offset:17408
    v_mfma_f32_16x16x32_bf16 v[32:35], a[20:23], v[144:147], v[32:35]
    v_mfma_f32_16x16x32_bf16 v[48:51], a[44:47], v[144:147], v[48:51]
    v_mfma_f32_16x16x32_bf16 v[64:67], a[68:71], v[144:147], v[64:67]
    v_mfma_f32_16x16x32_bf16 v[80:83], a[92:95], v[144:147], v[80:83]
    v_mfma_f32_16x16x32_bf16 v[36:39], a[20:23], v[148:151], v[36:39]
    v_cvt_pk_bf16_f32 v192, v96, v97
    v_cvt_pk_bf16_f32 v193, v98, v99
    v_mfma_f32_16x16x32_bf16 v[52:55], a[44:47], v[148:151], v[52:55]
    v_cvt_pk_bf16_f32 v194, v100, v101
    v_cvt_pk_bf16_f32 v195, v102, v103
    v_mfma_f32_16x16x32_bf16 v[68:71], a[68:71], v[148:151], v[68:71]
    v_cvt_pk_bf16_f32 v196, v104, v105
    v_cvt_pk_bf16_f32 v197, v106, v107
    v_mfma_f32_16x16x32_bf16 v[84:87], a[92:95], v[148:151], v[84:87]
    ds_read_b64 v[150:151], v27 offset:5120
    v_cndmask_b32 v80, v15, v80, s[44:45]
    v_mfma_f32_16x16x32_bf16 v[40:43], a[20:23], v[152:155], v[40:43]
    v_max3_f32 v16, v32, v33, v34
    v_max3_f32 v17, v35, v48, v49
    v_mfma_f32_16x16x32_bf16 v[56:59], a[44:47], v[152:155], v[56:59]
    v_max3_f32 v16, v16, v50, v51
    v_max3_f32 v17, v17, v64, v65
    v_mfma_f32_16x16x32_bf16 v[72:75], a[68:71], v[152:155], v[72:75]
    v_max3_f32 v16, v16, v66, v67
    v_mfma_f32_16x16x32_bf16 v[88:91], a[92:95], v[152:155], v[88:91]
    v_max3_f32 v16, v16, v17, v80
    s_waitcnt lgkmcnt(15)
    v_mfma_f32_16x16x32_bf16 v[112:115], a[0:3], a[120:123], 0
    v_mov_b32 v17, v16
    v_mfma_f32_16x16x32_bf16 v[116:119], a[24:27], a[120:123], 0
    v_mfma_f32_16x16x32_bf16 v[120:123], a[48:51], a[120:123], 0
    ds_read_b128 a[120:123], v8 offset:18432
    v_permlane32_swap_b32 v16, v17
    v_mfma_f32_16x16x32_bf16 v[112:115], a[4:7], a[124:127], v[112:115]
    v_max_f32 v16, v16, v17
    v_mfma_f32_16x16x32_bf16 v[116:119], a[28:31], a[124:127], v[116:119]
    v_mov_b32 v17, v16
    v_mfma_f32_16x16x32_bf16 v[120:123], a[52:55], a[124:127], v[120:123]
    ds_read_b128 a[124:127], v8 offset:19456
    v_permlane16_swap_b32 v16, v17
    v_mfma_f32_16x16x32_bf16 v[112:115], a[8:11], a[128:131], v[112:115]
    v_max_f32 v16, v16, v17
    v_mfma_f32_16x16x32_bf16 v[116:119], a[32:35], a[128:131], v[116:119]
    v_mul_f32 v16, s42, v16
    v_mfma_f32_16x16x32_bf16 v[120:123], a[56:59], a[128:131], v[120:123]
    ds_read_b128 a[128:131], v8 offset:20480
    v_fma_f32 v32, v32, s42, -v16
    v_mfma_f32_16x16x32_bf16 v[112:115], a[12:15], a[132:135], v[112:115]
    v_exp_f32 v32, v32
    v_mfma_f32_16x16x32_bf16 v[116:119], a[36:39], a[132:135], v[116:119]
    v_fma_f32 v33, v33, s42, -v16
    v_fma_f32 v34, v34, s42, -v16
    v_mfma_f32_16x16x32_bf16 v[120:123], a[60:63], a[132:135], v[120:123]
    ds_read_b128 a[132:135], v8 offset:21504
    v_fma_f32 v35, v35, s42, -v16
    v_mfma_f32_16x16x32_bf16 v[112:115], a[16:19], a[136:139], v[112:115]
    v_exp_f32 v33, v33
    v_mfma_f32_16x16x32_bf16 v[116:119], a[40:43], a[136:139], v[116:119]
    v_exp_f32 v34, v34
    v_mfma_f32_16x16x32_bf16 v[120:123], a[64:67], a[136:139], v[120:123]
    ds_read_b128 a[136:139], v8 offset:22528
    v_add_f32 v18, v32, v33
    v_mfma_f32_16x16x32_bf16 v[112:115], a[20:23], a[140:143], v[112:115]
    v_exp_f32 v35, v35
    v_mfma_f32_16x16x32_bf16 v[116:119], a[44:47], a[140:143], v[116:119]
    v_fma_f32 v48, v48, s42, -v16
    v_add_f32 v19, v34, v35
    v_mfma_f32_16x16x32_bf16 v[120:123], a[68:71], a[140:143], v[120:123]
    ds_read_b128 a[140:143], v8 offset:23552
    v_fma_f32 v49, v49, s42, -v16
    s_waitcnt lgkmcnt(15)
    v_mfma_f32_16x16x32_bf16 v[96:99], a[0:3], a[96:99], 0
    v_cvt_pk_bf16_f32 v200, v112, v113
    v_cvt_pk_bf16_f32 v201, v114, v115
    v_mfma_f32_16x16x32_bf16 v[100:103], a[24:27], a[96:99], 0
    v_cvt_pk_bf16_f32 v202, v116, v117
    v_cvt_pk_bf16_f32 v203, v118, v119
    v_mfma_f32_16x16x32_bf16 v[104:107], a[48:51], a[96:99], 0
    v_cvt_pk_bf16_f32 v204, v120, v121
    v_cvt_pk_bf16_f32 v205, v122, v123
    v_mfma_f32_16x16x32_bf16 v[96:99], a[4:7], a[100:103], v[96:99]
    ds_read_b128 a[96:99], v8 offset:24576
    v_fma_f32 v50, v50, s42, -v16
    v_mfma_f32_16x16x32_bf16 v[100:103], a[28:31], a[100:103], v[100:103]
    v_exp_f32 v48, v48
    v_mfma_f32_16x16x32_bf16 v[104:107], a[52:55], a[100:103], v[104:107]
    ds_read_b128 a[100:103], v8 offset:25600
    v_add_f32 v19, v19, v48
    s_waitcnt lgkmcnt(12)
    v_mfma_f32_16x16x32_bf16 v[96:99], a[8:11], a[104:107], v[96:99]
    v_exp_f32 v49, v49
    v_mfma_f32_16x16x32_bf16 v[100:103], a[32:35], a[104:107], v[100:103]
    v_exp_f32 v50, v50
    v_mfma_f32_16x16x32_bf16 v[104:107], a[56:59], a[104:107], v[104:107]
    ds_read_b128 a[104:107], v8 offset:26624
    v_add_f32 v18, v18, v49
    s_waitcnt lgkmcnt(12)
    v_mfma_f32_16x16x32_bf16 v[96:99], a[12:15], a[108:111], v[96:99]
    v_fma_f32 v51, v51, s42, -v16
    v_add_f32 v19, v19, v50
    v_mfma_f32_16x16x32_bf16 v[100:103], a[36:39], a[108:111], v[100:103]
    v_exp_f32 v51, v51
    v_mfma_f32_16x16x32_bf16 v[104:107], a[60:63], a[108:111], v[104:107]
    ds_read_b128 a[108:111], v8 offset:27648
    v_fma_f32 v64, v64, s42, -v16
    s_waitcnt lgkmcnt(12)
    v_mfma_f32_16x16x32_bf16 v[96:99], a[16:19], a[112:115], v[96:99]
    v_exp_f32 v64, v64
    v_mfma_f32_16x16x32_bf16 v[100:103], a[40:43], a[112:115], v[100:103]
    v_add_f32 v18, v18, v51
    v_fma_f32 v65, v65, s42, -v16
    v_mfma_f32_16x16x32_bf16 v[104:107], a[64:67], a[112:115], v[104:107]
    ds_read_b128 a[112:115], v8 offset:28672
    v_add_f32 v19, v19, v64
    s_waitcnt lgkmcnt(12)
    v_mfma_f32_16x16x32_bf16 v[96:99], a[20:23], a[116:119], v[96:99]
    v_exp_f32 v65, v65
    v_mfma_f32_16x16x32_bf16 v[100:103], a[44:47], a[116:119], v[100:103]
    v_fma_f32 v66, v66, s42, -v16
    v_add_f32 v18, v18, v65
    v_mfma_f32_16x16x32_bf16 v[104:107], a[68:71], a[116:119], v[104:107]
    ds_read_b128 a[116:119], v8 offset:29696
    v_fma_f32 v67, v67, s42, -v16
    v_mfma_f32_16x16x32_bf16 v[44:47], v[192:195], v[184:187], 0
    v_cvt_pk_bf16_f32 v208, v96, v97
    v_cvt_pk_bf16_f32 v209, v98, v99
    v_mfma_f32_16x16x32_bf16 v[44:47], v[196:199], v[188:191], v[44:47]
    v_cvt_pk_bf16_f32 v210, v100, v101
    v_cvt_pk_bf16_f32 v211, v102, v103
    v_mfma_f32_16x16x32_bf16 v[60:63], v[200:203], v[184:187], 0
    v_cvt_pk_bf16_f32 v212, v104, v105
    v_cvt_pk_bf16_f32 v213, v106, v107
    v_mfma_f32_16x16x32_bf16 v[60:63], v[204:207], v[188:191], v[60:63]
    v_exp_f32 v66, v66
    s_waitcnt lgkmcnt(11)
    v_mfma_f32_16x16x32_bf16 v[112:115], a[0:3], a[120:123], 0
    v_cvt_pk_bf16_f32 v44, v44, v45
    v_cvt_pk_bf16_f32 v45, v46, v47
    v_mfma_f32_16x16x32_bf16 v[116:119], a[24:27], a[120:123], 0
    v_exp_f32 v67, v67
    v_mfma_f32_16x16x32_bf16 v[120:123], a[48:51], a[120:123], 0
    ds_read_b128 a[120:123], v8 offset:30720
    v_cvt_pk_bf16_f32 v46, v60, v61
    s_waitcnt lgkmcnt(11)
    v_mfma_f32_16x16x32_bf16 v[112:115], a[4:7], a[124:127], v[112:115]
    v_cvt_pk_bf16_f32 v47, v62, v63
    v_add_f32 v19, v19, v66
    v_mfma_f32_16x16x32_bf16 v[116:119], a[28:31], a[124:127], v[116:119]
    buffer_store_dwordx4 v[44:47], v6, s[24:27], 0 offen offset:0 sc1 nt
    v_fma_f32 v80, v80, s42, -v16
    v_mfma_f32_16x16x32_bf16 v[120:123], a[52:55], a[124:127], v[120:123]
    ds_read_b128 a[124:127], v8 offset:31744
    v_add_f32 v18, v18, v67
    s_waitcnt lgkmcnt(11)
    v_mfma_f32_16x16x32_bf16 v[112:115], a[8:11], a[128:131], v[112:115]
    v_exp_f32 v80, v80
    v_mfma_f32_16x16x32_bf16 v[116:119], a[32:35], a[128:131], v[116:119]
    v_add_f32 v19, v19, v80
    v_mfma_f32_16x16x32_bf16 v[120:123], a[56:59], a[128:131], v[120:123]
    ds_read_b128 a[128:131], v8 offset:32768
    v_add_f32 v18, v18, v19
    s_waitcnt lgkmcnt(11)
    v_mfma_f32_16x16x32_bf16 v[112:115], a[12:15], a[132:135], v[112:115]
    v_mov_b32 v19, v18
    v_mfma_f32_16x16x32_bf16 v[116:119], a[36:39], a[132:135], v[116:119]
    v_mfma_f32_16x16x32_bf16 v[120:123], a[60:63], a[132:135], v[120:123]
    ds_read_b128 a[132:135], v8 offset:33792
    v_permlane32_swap_b32 v18, v19
    s_waitcnt lgkmcnt(11)
    v_mfma_f32_16x16x32_bf16 v[112:115], a[16:19], a[136:139], v[112:115]
    v_add_f32 v18, v18, v19
    v_mfma_f32_16x16x32_bf16 v[116:119], a[40:43], a[136:139], v[116:119]
    v_mov_b32 v19, v18
    v_mfma_f32_16x16x32_bf16 v[120:123], a[64:67], a[136:139], v[120:123]
    ds_read_b128 a[136:139], v8 offset:34816
    v_permlane16_swap_b32 v18, v19
    s_waitcnt lgkmcnt(11)
    v_mfma_f32_16x16x32_bf16 v[112:115], a[20:23], a[140:143], v[112:115]
    v_add_f32 v18, v18, v19
    v_mfma_f32_16x16x32_bf16 v[116:119], a[44:47], a[140:143], v[116:119]
    v_rcp_f32 v18, v18
    v_mfma_f32_16x16x32_bf16 v[120:123], a[68:71], a[140:143], v[120:123]
    ds_read_b128 a[140:143], v8 offset:35840
    v_mul_f32 v32, v32, v18
    s_waitcnt lgkmcnt(11)
    v_mfma_f32_16x16x32_bf16 v[96:99], a[0:3], a[96:99], 0
    v_mul_f32 v33, v33, v18
    v_cvt_pk_bf16_f32 v216, v112, v113
    v_mfma_f32_16x16x32_bf16 v[100:103], a[24:27], a[96:99], 0
    v_cvt_pk_bf16_f32 v217, v114, v115
    v_cvt_pk_bf16_f32 v218, v116, v117
    v_mfma_f32_16x16x32_bf16 v[104:107], a[48:51], a[96:99], 0
    v_cvt_pk_bf16_f32 v219, v118, v119
    v_cvt_pk_bf16_f32 v220, v120, v121
    s_waitcnt lgkmcnt(10)
    v_mfma_f32_16x16x32_bf16 v[96:99], a[4:7], a[100:103], v[96:99]
    v_cvt_pk_bf16_f32 v221, v122, v123
    ds_read_b128 a[96:99], v8 offset:36864
    v_mfma_f32_16x16x32_bf16 v[100:103], a[28:31], a[100:103], v[100:103]
    v_cvt_pk_bf16_f32 v160, v32, v33
    v_mul_f32 v34, v34, v18
    v_mfma_f32_16x16x32_bf16 v[104:107], a[52:55], a[100:103], v[104:107]
    ds_read_b128 a[100:103], v8 offset:37888
    v_mul_f32 v35, v35, v18
    s_waitcnt lgkmcnt(11)
    v_mfma_f32_16x16x32_bf16 v[96:99], a[8:11], a[104:107], v[96:99]
    v_cvt_pk_bf16_f32 v161, v34, v35
    v_mul_f32 v48, v48, v18
    v_mfma_f32_16x16x32_bf16 v[100:103], a[32:35], a[104:107], v[100:103]
    v_mul_f32 v49, v49, v18
    v_mul_f32 v50, v50, v18
    v_mfma_f32_16x16x32_bf16 v[104:107], a[56:59], a[104:107], v[104:107]
    ds_read_b128 a[104:107], v8 offset:38912
    v_cvt_pk_bf16_f32 v162, v48, v49
    s_waitcnt lgkmcnt(11)
    v_mfma_f32_16x16x32_bf16 v[96:99], a[12:15], a[108:111], v[96:99]
    v_mul_f32 v51, v51, v18
    v_mul_f32 v64, v64, v18
    v_mfma_f32_16x16x32_bf16 v[100:103], a[36:39], a[108:111], v[100:103]
    v_cvt_pk_bf16_f32 v163, v50, v51
    v_mul_f32 v65, v65, v18
    v_mfma_f32_16x16x32_bf16 v[104:107], a[60:63], a[108:111], v[104:107]
    ds_read_b128 a[108:111], v8 offset:39936
    v_cvt_pk_bf16_f32 v164, v64, v65
    s_waitcnt lgkmcnt(11)
    v_mfma_f32_16x16x32_bf16 v[96:99], a[16:19], a[112:115], v[96:99]
    v_mul_f32 v66, v66, v18
    v_mul_f32 v67, v67, v18
    v_mfma_f32_16x16x32_bf16 v[100:103], a[40:43], a[112:115], v[100:103]
    v_cvt_pk_bf16_f32 v165, v66, v67
    v_mul_f32 v80, v80, v18
    v_mfma_f32_16x16x32_bf16 v[104:107], a[64:67], a[112:115], v[104:107]
    ds_read_b128 a[112:115], v8 offset:40960
    v_cvt_pk_bf16_f32 v166, v80, 0
    s_waitcnt lgkmcnt(11)
    v_mfma_f32_16x16x32_bf16 v[96:99], a[20:23], a[116:119], v[96:99]
    v_mov_b32 v167, 0
    v_cndmask_b32 v84, v15, v84, s[44:45]
    v_mfma_f32_16x16x32_bf16 v[100:103], a[44:47], a[116:119], v[100:103]
    v_max3_f32 v20, v36, v37, v38
    v_max3_f32 v21, v39, v52, v53
    v_mfma_f32_16x16x32_bf16 v[104:107], a[68:71], a[116:119], v[104:107]
    ds_read_b128 a[116:119], v8 offset:41984
    v_max3_f32 v20, v20, v54, v55
    v_mfma_f32_16x16x32_bf16 v[76:79], v[208:211], v[184:187], 0
    v_cvt_pk_bf16_f32 v224, v96, v97
    v_cvt_pk_bf16_f32 v225, v98, v99
    v_mfma_f32_16x16x32_bf16 v[76:79], v[212:215], v[188:191], v[76:79]
    v_cvt_pk_bf16_f32 v226, v100, v101
    v_cvt_pk_bf16_f32 v227, v102, v103
    v_mfma_f32_16x16x32_bf16 v[92:95], v[216:219], v[184:187], 0
    v_cvt_pk_bf16_f32 v228, v104, v105
    v_cvt_pk_bf16_f32 v229, v106, v107
    v_mfma_f32_16x16x32_bf16 v[92:95], v[220:223], v[188:191], v[92:95]
    v_max3_f32 v21, v21, v68, v69
    v_max3_f32 v20, v20, v70, v71
    v_mfma_f32_16x16x32_bf16 v[32:35], v[192:195], v[160:163], 0
    v_cvt_pk_bf16_f32 v76, v76, v77
    v_cvt_pk_bf16_f32 v77, v78, v79
    v_mfma_f32_16x16x32_bf16 v[32:35], v[196:199], v[164:167], v[32:35]
    v_max3_f32 v20, v20, v21, v84
    v_mfma_f32_16x16x32_bf16 v[48:51], v[200:203], v[160:163], 0
    v_cvt_pk_bf16_f32 v78, v92, v93
    v_cvt_pk_bf16_f32 v79, v94, v95
    v_mfma_f32_16x16x32_bf16 v[48:51], v[204:207], v[164:167], v[48:51]
    buffer_store_dwordx4 v[76:79], v6, s[24:27], 0 offen offset:64 sc1 nt
    v_mov_b32 v21, v20
    v_mfma_f32_16x16x32_bf16 v[64:67], v[208:211], v[160:163], 0
    v_cvt_pk_bf16_f32 v32, v32, v33
    v_cvt_pk_bf16_f32 v33, v34, v35
    v_mfma_f32_16x16x32_bf16 v[64:67], v[212:215], v[164:167], v[64:67]
    v_permlane32_swap_b32 v20, v21
    v_mfma_f32_16x16x32_bf16 v[80:83], v[216:219], v[160:163], 0
    v_cvt_pk_bf16_f32 v34, v48, v49
    v_cvt_pk_bf16_f32 v35, v50, v51
    v_mfma_f32_16x16x32_bf16 v[80:83], v[220:223], v[164:167], v[80:83]
    buffer_store_dwordx4 v[32:35], v2, s[24:27], 0 offen offset:0 sc1 nt
    v_max_f32 v20, v20, v21
    s_waitcnt lgkmcnt(11)
    v_mfma_f32_16x16x32_bf16 v[112:115], a[0:3], a[120:123], 0
    v_cvt_pk_bf16_f32 v64, v64, v65
    v_cvt_pk_bf16_f32 v65, v66, v67
    v_mfma_f32_16x16x32_bf16 v[116:119], a[24:27], a[120:123], 0
    v_mov_b32 v21, v20
    v_mfma_f32_16x16x32_bf16 v[120:123], a[48:51], a[120:123], 0
    v_cvt_pk_bf16_f32 v66, v80, v81
    v_cvt_pk_bf16_f32 v67, v82, v83
    s_waitcnt lgkmcnt(10)
    v_mfma_f32_16x16x32_bf16 v[112:115], a[4:7], a[124:127], v[112:115]
    buffer_store_dwordx4 v[64:67], v2, s[24:27], 0 offen offset:64 sc1 nt
    ds_read_b128 a[120:123], v8 offset:43008
    v_mfma_f32_16x16x32_bf16 v[116:119], a[28:31], a[124:127], v[116:119]
    v_permlane16_swap_b32 v20, v21
    v_mfma_f32_16x16x32_bf16 v[120:123], a[52:55], a[124:127], v[120:123]
    ds_read_b128 a[124:127], v8 offset:44032
    v_max_f32 v20, v20, v21
    s_waitcnt lgkmcnt(11)
    v_mfma_f32_16x16x32_bf16 v[112:115], a[8:11], a[128:131], v[112:115]
    v_mul_f32 v20, s42, v20
    v_mfma_f32_16x16x32_bf16 v[116:119], a[32:35], a[128:131], v[116:119]
    v_fma_f32 v36, v36, s42, -v20
    v_fma_f32 v37, v37, s42, -v20
    v_mfma_f32_16x16x32_bf16 v[120:123], a[56:59], a[128:131], v[120:123]
    ds_read_b128 a[128:131], v8 offset:45056
    v_fma_f32 v38, v38, s42, -v20
    s_waitcnt lgkmcnt(11)
    v_mfma_f32_16x16x32_bf16 v[112:115], a[12:15], a[132:135], v[112:115]
    v_exp_f32 v36, v36
    v_mfma_f32_16x16x32_bf16 v[116:119], a[36:39], a[132:135], v[116:119]
    v_exp_f32 v37, v37
    v_mfma_f32_16x16x32_bf16 v[120:123], a[60:63], a[132:135], v[120:123]
    ds_read_b128 a[132:135], v8 offset:46080
    v_fma_f32 v39, v39, s42, -v20
    s_waitcnt lgkmcnt(11)
    v_mfma_f32_16x16x32_bf16 v[112:115], a[16:19], a[136:139], v[112:115]
    v_exp_f32 v38, v38
    v_mfma_f32_16x16x32_bf16 v[116:119], a[40:43], a[136:139], v[116:119]
    v_exp_f32 v39, v39
    v_mfma_f32_16x16x32_bf16 v[120:123], a[64:67], a[136:139], v[120:123]
    ds_read_b128 a[136:139], v8 offset:47104
    v_add_f32 v22, v36, v37
    s_waitcnt lgkmcnt(11)
    v_mfma_f32_16x16x32_bf16 v[112:115], a[20:23], a[140:143], v[112:115]
    v_fma_f32 v52, v52, s42, -v20
    v_add_f32 v23, v38, v39
    v_mfma_f32_16x16x32_bf16 v[116:119], a[44:47], a[140:143], v[116:119]
    v_exp_f32 v52, v52
    v_mfma_f32_16x16x32_bf16 v[120:123], a[68:71], a[140:143], v[120:123]
    ds_read_b128 a[140:143], v8 offset:48128
    v_fma_f32 v53, v53, s42, -v20
    s_waitcnt lgkmcnt(11)
    v_mfma_f32_16x16x32_bf16 v[96:99], a[0:3], a[96:99], 0
    v_cvt_pk_bf16_f32 v232, v112, v113
    v_cvt_pk_bf16_f32 v233, v114, v115
    v_mfma_f32_16x16x32_bf16 v[100:103], a[24:27], a[96:99], 0
    v_cvt_pk_bf16_f32 v234, v116, v117
    v_cvt_pk_bf16_f32 v235, v118, v119
    v_mfma_f32_16x16x32_bf16 v[104:107], a[48:51], a[96:99], 0
    v_cvt_pk_bf16_f32 v236, v120, v121
    v_cvt_pk_bf16_f32 v237, v122, v123
    s_waitcnt lgkmcnt(10)
    v_mfma_f32_16x16x32_bf16 v[96:99], a[4:7], a[100:103], v[96:99]
    ds_read_b128 a[96:99], v9 offset:0
    v_add_f32 v23, v23, v52
    v_mfma_f32_16x16x32_bf16 v[100:103], a[28:31], a[100:103], v[100:103]
    v_exp_f32 v53, v53
    v_mfma_f32_16x16x32_bf16 v[104:107], a[52:55], a[100:103], v[104:107]
    ds_read_b128 a[100:103], v9 offset:1024
    v_fma_f32 v54, v54, s42, -v20
    s_waitcnt lgkmcnt(11)
    v_mfma_f32_16x16x32_bf16 v[96:99], a[8:11], a[104:107], v[96:99]
    v_exp_f32 v54, v54
    v_mfma_f32_16x16x32_bf16 v[100:103], a[32:35], a[104:107], v[100:103]
    v_add_f32 v22, v22, v53
    v_fma_f32 v55, v55, s42, -v20
    v_mfma_f32_16x16x32_bf16 v[104:107], a[56:59], a[104:107], v[104:107]
    ds_read_b128 a[104:107], v9 offset:2048
    v_add_f32 v23, v23, v54
    s_waitcnt lgkmcnt(11)
    v_mfma_f32_16x16x32_bf16 v[96:99], a[12:15], a[108:111], v[96:99]
    v_exp_f32 v55, v55
    v_mfma_f32_16x16x32_bf16 v[100:103], a[36:39], a[108:111], v[100:103]
    v_fma_f32 v68, v68, s42, -v20
    v_add_f32 v22, v22, v55
    v_mfma_f32_16x16x32_bf16 v[104:107], a[60:63], a[108:111], v[104:107]
    ds_read_b128 a[108:111], v9 offset:3072
    v_fma_f32 v69, v69, s42, -v20
    s_waitcnt lgkmcnt(11)
    v_mfma_f32_16x16x32_bf16 v[96:99], a[16:19], a[112:115], v[96:99]
    v_exp_f32 v68, v68
    v_mfma_f32_16x16x32_bf16 v[100:103], a[40:43], a[112:115], v[100:103]
    v_exp_f32 v69, v69
    v_mfma_f32_16x16x32_bf16 v[104:107], a[64:67], a[112:115], v[104:107]
    ds_read_b128 a[112:115], v9 offset:4096
    v_add_f32 v23, v23, v68
    s_waitcnt lgkmcnt(11)
    v_mfma_f32_16x16x32_bf16 v[96:99], a[20:23], a[116:119], v[96:99]
    v_fma_f32 v70, v70, s42, -v20
    v_add_f32 v22, v22, v69
    v_mfma_f32_16x16x32_bf16 v[100:103], a[44:47], a[116:119], v[100:103]
    v_exp_f32 v70, v70
    v_mfma_f32_16x16x32_bf16 v[104:107], a[68:71], a[116:119], v[104:107]
    ds_read_b128 a[116:119], v9 offset:5120
    v_fma_f32 v71, v71, s42, -v20
    v_mfma_f32_16x16x32_bf16 v[32:35], v[224:227], v[160:163], 0
    v_cvt_pk_bf16_f32 v240, v96, v97
    v_cvt_pk_bf16_f32 v241, v98, v99
    v_mfma_f32_16x16x32_bf16 v[32:35], v[228:231], v[164:167], v[32:35]
    v_cvt_pk_bf16_f32 v242, v100, v101
    v_cvt_pk_bf16_f32 v243, v102, v103
    v_mfma_f32_16x16x32_bf16 v[48:51], v[232:235], v[160:163], 0
    v_cvt_pk_bf16_f32 v244, v104, v105
    v_cvt_pk_bf16_f32 v245, v106, v107
    v_mfma_f32_16x16x32_bf16 v[48:51], v[236:239], v[164:167], v[48:51]
    v_exp_f32 v71, v71
    v_mfma_f32_16x16x32_bf16 v[44:47], v[224:227], v[184:187], 0
    v_cvt_pk_bf16_f32 v32, v32, v33
    v_cvt_pk_bf16_f32 v33, v34, v35
    v_mfma_f32_16x16x32_bf16 v[44:47], v[228:231], v[188:191], v[44:47]
    v_add_f32 v23, v23, v70
    v_fma_f32 v84, v84, s42, -v20
    v_mfma_f32_16x16x32_bf16 v[60:63], v[232:235], v[184:187], 0
    v_cvt_pk_bf16_f32 v34, v48, v49
    v_cvt_pk_bf16_f32 v35, v50, v51
    v_mfma_f32_16x16x32_bf16 v[60:63], v[236:239], v[188:191], v[60:63]
    buffer_store_dwordx4 v[32:35], v2, s[24:27], 0 offen offset:128 sc1 nt
    v_add_f32 v22, v22, v71
    s_waitcnt lgkmcnt(11)
    v_mfma_f32_16x16x32_bf16 v[112:115], a[0:3], a[120:123], 0
    v_cvt_pk_bf16_f32 v44, v44, v45
    v_cvt_pk_bf16_f32 v45, v46, v47
    v_mfma_f32_16x16x32_bf16 v[116:119], a[24:27], a[120:123], 0
    v_exp_f32 v84, v84
    v_mfma_f32_16x16x32_bf16 v[120:123], a[48:51], a[120:123], 0
    v_cvt_pk_bf16_f32 v46, v60, v61
    v_cvt_pk_bf16_f32 v47, v62, v63
    s_waitcnt lgkmcnt(10)
    v_mfma_f32_16x16x32_bf16 v[112:115], a[4:7], a[124:127], v[112:115]
    buffer_store_dwordx4 v[44:47], v6, s[24:27], 0 offen offset:128 sc1 nt
    ds_read_b128 a[120:123], v9 offset:6144
    v_mfma_f32_16x16x32_bf16 v[116:119], a[28:31], a[124:127], v[116:119]
    v_add_f32 v23, v23, v84
    v_mfma_f32_16x16x32_bf16 v[120:123], a[52:55], a[124:127], v[120:123]
    ds_read_b128 a[124:127], v9 offset:7168
    v_add_f32 v22, v22, v23
    s_waitcnt lgkmcnt(11)
    v_mfma_f32_16x16x32_bf16 v[112:115], a[8:11], a[128:131], v[112:115]
    v_mov_b32 v23, v22
    v_mfma_f32_16x16x32_bf16 v[116:119], a[32:35], a[128:131], v[116:119]
    v_mfma_f32_16x16x32_bf16 v[120:123], a[56:59], a[128:131], v[120:123]
    ds_read_b128 a[128:131], v9 offset:8192
    v_permlane32_swap_b32 v22, v23
    s_waitcnt lgkmcnt(11)
    v_mfma_f32_16x16x32_bf16 v[112:115], a[12:15], a[132:135], v[112:115]
    v_add_f32 v22, v22, v23
    v_mfma_f32_16x16x32_bf16 v[116:119], a[36:39], a[132:135], v[116:119]
    v_mov_b32 v23, v22
    v_mfma_f32_16x16x32_bf16 v[120:123], a[60:63], a[132:135], v[120:123]
    ds_read_b128 a[132:135], v9 offset:9216
    v_permlane16_swap_b32 v22, v23
    s_waitcnt lgkmcnt(11)
    v_mfma_f32_16x16x32_bf16 v[112:115], a[16:19], a[136:139], v[112:115]
    v_add_f32 v22, v22, v23
    v_mfma_f32_16x16x32_bf16 v[116:119], a[40:43], a[136:139], v[116:119]
    v_rcp_f32 v22, v22
    v_mfma_f32_16x16x32_bf16 v[120:123], a[64:67], a[136:139], v[120:123]
    ds_read_b128 a[136:139], v9 offset:10240
    v_mul_f32 v36, v36, v22
    s_waitcnt lgkmcnt(11)
    v_mfma_f32_16x16x32_bf16 v[112:115], a[20:23], a[140:143], v[112:115]
    v_mul_f32 v37, v37, v22
    v_mul_f32 v38, v38, v22
    v_mfma_f32_16x16x32_bf16 v[116:119], a[44:47], a[140:143], v[116:119]
    v_cvt_pk_bf16_f32 v168, v36, v37
    v_mul_f32 v39, v39, v22
    v_mfma_f32_16x16x32_bf16 v[120:123], a[68:71], a[140:143], v[120:123]
    ds_read_b128 a[140:143], v9 offset:11264
    v_cvt_pk_bf16_f32 v169, v38, v39
    v_cvt_pk_bf16_f32 v248, v112, v113
    v_cvt_pk_bf16_f32 v249, v114, v115
    v_mul_f32 v52, v52, v22
    v_cvt_pk_bf16_f32 v250, v116, v117
    v_cvt_pk_bf16_f32 v251, v118, v119
    v_mul_f32 v53, v53, v22
    v_mul_f32 v54, v54, v22
    v_cvt_pk_bf16_f32 v252, v120, v121
    v_cvt_pk_bf16_f32 v253, v122, v123
    v_cvt_pk_bf16_f32 v170, v52, v53
    v_mul_f32 v55, v55, v22
    v_mul_f32 v68, v68, v22
    v_cvt_pk_bf16_f32 v171, v54, v55
    v_mul_f32 v69, v69, v22
    v_mul_f32 v70, v70, v22
    v_mfma_f32_16x16x32_bf16 v[36:39], v[192:195], v[168:171], 0
    v_cvt_pk_bf16_f32 v172, v68, v69
    v_mul_f32 v71, v71, v22
    v_mul_f32 v84, v84, v22
    v_cvt_pk_bf16_f32 v173, v70, v71
    v_cvt_pk_bf16_f32 v174, v84, 0
    v_mov_b32 v175, 0
    v_cndmask_b32 v88, v15, v88, s[44:45]
    v_max3_f32 v16, v40, v41, v42
    v_mfma_f32_16x16x32_bf16 v[36:39], v[196:199], v[172:175], v[36:39]
    v_max3_f32 v17, v43, v56, v57
    v_max3_f32 v16, v16, v58, v59
    v_mfma_f32_16x16x32_bf16 v[52:55], v[200:203], v[168:171], 0
    v_max3_f32 v17, v17, v72, v73
    v_max3_f32 v16, v16, v74, v75
    v_mfma_f32_16x16x32_bf16 v[52:55], v[204:207], v[172:175], v[52:55]
    v_max3_f32 v16, v16, v17, v88
    v_mfma_f32_16x16x32_bf16 v[68:71], v[208:211], v[168:171], 0
    v_cvt_pk_bf16_f32 v36, v36, v37
    v_cvt_pk_bf16_f32 v37, v38, v39
    v_mfma_f32_16x16x32_bf16 v[68:71], v[212:215], v[172:175], v[68:71]
    v_mov_b32 v17, v16
    v_mfma_f32_16x16x32_bf16 v[84:87], v[216:219], v[168:171], 0
    v_mfma_f32_16x16x32_bf16 v[84:87], v[220:223], v[172:175], v[84:87]
    v_cvt_pk_bf16_f32 v38, v52, v53
    v_cvt_pk_bf16_f32 v39, v54, v55
    s_waitcnt lgkmcnt(11)
    v_mfma_f32_16x16x32_bf16 v[96:99], a[0:3], a[96:99], 0
    buffer_store_dwordx4 v[36:39], v3, s[24:27], 0 offen offset:0 sc1 nt
    v_permlane32_swap_b32 v16, v17
    v_mfma_f32_16x16x32_bf16 v[100:103], a[24:27], a[96:99], 0
    v_cvt_pk_bf16_f32 v68, v68, v69
    v_cvt_pk_bf16_f32 v69, v70, v71
    v_mfma_f32_16x16x32_bf16 v[104:107], a[48:51], a[96:99], 0
    v_cvt_pk_bf16_f32 v70, v84, v85
    v_cvt_pk_bf16_f32 v71, v86, v87
    s_waitcnt lgkmcnt(10)
    v_mfma_f32_16x16x32_bf16 v[96:99], a[4:7], a[100:103], v[96:99]
    buffer_store_dwordx4 v[68:71], v3, s[24:27], 0 offen offset:64 sc1 nt
    ds_read_b128 a[96:99], v9 offset:12288
    v_mfma_f32_16x16x32_bf16 v[100:103], a[28:31], a[100:103], v[100:103]
    v_max_f32 v16, v16, v17
    v_mfma_f32_16x16x32_bf16 v[104:107], a[52:55], a[100:103], v[104:107]
    ds_read_b128 a[100:103], v9 offset:13312
    v_mov_b32 v17, v16
    s_waitcnt lgkmcnt(11)
    v_mfma_f32_16x16x32_bf16 v[96:99], a[8:11], a[104:107], v[96:99]
    v_mfma_f32_16x16x32_bf16 v[100:103], a[32:35], a[104:107], v[100:103]
    v_permlane16_swap_b32 v16, v17
    v_mfma_f32_16x16x32_bf16 v[104:107], a[56:59], a[104:107], v[104:107]
    ds_read_b128 a[104:107], v9 offset:14336
    v_max_f32 v16, v16, v17
    s_waitcnt lgkmcnt(11)
    v_mfma_f32_16x16x32_bf16 v[96:99], a[12:15], a[108:111], v[96:99]
    v_mul_f32 v16, s42, v16
    v_mfma_f32_16x16x32_bf16 v[100:103], a[36:39], a[108:111], v[100:103]
    v_fma_f32 v40, v40, s42, -v16
    v_fma_f32 v41, v41, s42, -v16
    v_mfma_f32_16x16x32_bf16 v[104:107], a[60:63], a[108:111], v[104:107]
    ds_read_b128 a[108:111], v9 offset:15360
    v_fma_f32 v42, v42, s42, -v16
    s_waitcnt lgkmcnt(11)
    v_mfma_f32_16x16x32_bf16 v[96:99], a[16:19], a[112:115], v[96:99]
    v_exp_f32 v40, v40
    v_mfma_f32_16x16x32_bf16 v[100:103], a[40:43], a[112:115], v[100:103]
    v_exp_f32 v41, v41
    v_mfma_f32_16x16x32_bf16 v[104:107], a[64:67], a[112:115], v[104:107]
    ds_read_b128 a[112:115], v9 offset:16384
    v_fma_f32 v43, v43, s42, -v16
    s_waitcnt lgkmcnt(11)
    v_mfma_f32_16x16x32_bf16 v[96:99], a[20:23], a[116:119], v[96:99]
    v_exp_f32 v42, v42
    v_mfma_f32_16x16x32_bf16 v[100:103], a[44:47], a[116:119], v[100:103]
    v_exp_f32 v43, v43
    v_mfma_f32_16x16x32_bf16 v[104:107], a[68:71], a[116:119], v[104:107]
    ds_read_b128 a[116:119], v9 offset:17408
    v_add_f32 v18, v40, v41
    v_mfma_f32_16x16x32_bf16 v[36:39], v[224:227], v[168:171], 0
    v_fma_f32 v56, v56, s42, -v16
    v_cvt_pk_bf16_f32 v128, v96, v97
    v_mfma_f32_16x16x32_bf16 v[36:39], v[228:231], v[172:175], v[36:39]
    v_cvt_pk_bf16_f32 v129, v98, v99
    v_cvt_pk_bf16_f32 v130, v100, v101
    v_mfma_f32_16x16x32_bf16 v[52:55], v[232:235], v[168:171], 0
    v_cvt_pk_bf16_f32 v131, v102, v103
    v_cvt_pk_bf16_f32 v132, v104, v105
    v_mfma_f32_16x16x32_bf16 v[52:55], v[236:239], v[172:175], v[52:55]
    v_cvt_pk_bf16_f32 v133, v106, v107
    v_add_f32 v19, v42, v43
    v_mfma_f32_16x16x32_bf16 v[64:67], v[240:243], v[160:163], 0
    v_cvt_pk_bf16_f32 v36, v36, v37
    v_cvt_pk_bf16_f32 v37, v38, v39
    v_mfma_f32_16x16x32_bf16 v[64:67], v[244:247], v[164:167], v[64:67]
    v_exp_f32 v56, v56
    v_mfma_f32_16x16x32_bf16 v[80:83], v[248:251], v[160:163], 0
    v_cvt_pk_bf16_f32 v38, v52, v53
    v_cvt_pk_bf16_f32 v39, v54, v55
    v_mfma_f32_16x16x32_bf16 v[80:83], v[252:255], v[164:167], v[80:83]
    buffer_store_dwordx4 v[36:39], v3, s[24:27], 0 offen offset:128 sc1 nt
    v_fma_f32 v57, v57, s42, -v16
    v_mfma_f32_16x16x32_bf16 v[76:79], v[240:243], v[184:187], 0
    v_cvt_pk_bf16_f32 v64, v64, v65
    v_cvt_pk_bf16_f32 v65, v66, v67
    v_mfma_f32_16x16x32_bf16 v[76:79], v[244:247], v[188:191], v[76:79]
    v_exp_f32 v57, v57
    v_mfma_f32_16x16x32_bf16 v[92:95], v[248:251], v[184:187], 0
    v_cvt_pk_bf16_f32 v66, v80, v81
    v_cvt_pk_bf16_f32 v67, v82, v83
    v_mfma_f32_16x16x32_bf16 v[92:95], v[252:255], v[188:191], v[92:95]
    buffer_store_dwordx4 v[64:67], v2, s[24:27], 0 offen offset:192 sc1 nt
    v_add_f32 v19, v19, v56
    v_mfma_f32_16x16x32_bf16 v[68:71], v[240:243], v[168:171], 0
    v_cvt_pk_bf16_f32 v76, v76, v77
    v_cvt_pk_bf16_f32 v77, v78, v79
    v_mfma_f32_16x16x32_bf16 v[68:71], v[244:247], v[172:175], v[68:71]
    v_fma_f32 v58, v58, s42, -v16
    v_add_f32 v18, v18, v57
    v_mfma_f32_16x16x32_bf16 v[84:87], v[248:251], v[168:171], 0
    v_cvt_pk_bf16_f32 v78, v92, v93
    v_cvt_pk_bf16_f32 v79, v94, v95
    v_mfma_f32_16x16x32_bf16 v[84:87], v[252:255], v[172:175], v[84:87]
    buffer_store_dwordx4 v[76:79], v6, s[24:27], 0 offen offset:192 sc1 nt
    v_fma_f32 v59, v59, s42, -v16
    s_waitcnt lgkmcnt(11)
    v_mfma_f32_16x16x32_bf16 v[112:115], a[0:3], a[120:123], 0
    v_cvt_pk_bf16_f32 v68, v68, v69
    v_cvt_pk_bf16_f32 v69, v70, v71
    v_mfma_f32_16x16x32_bf16 v[116:119], a[24:27], a[120:123], 0
    v_exp_f32 v58, v58
    v_mfma_f32_16x16x32_bf16 v[120:123], a[48:51], a[120:123], 0
    v_cvt_pk_bf16_f32 v70, v84, v85
    v_cvt_pk_bf16_f32 v71, v86, v87
    s_waitcnt lgkmcnt(10)
    v_mfma_f32_16x16x32_bf16 v[112:115], a[4:7], a[124:127], v[112:115]
    buffer_store_dwordx4 v[68:71], v3, s[24:27], 0 offen offset:192 sc1 nt
    ds_read_b128 a[120:123], v9 offset:18432
    v_mfma_f32_16x16x32_bf16 v[116:119], a[28:31], a[124:127], v[116:119]
    v_exp_f32 v59, v59
    v_mfma_f32_16x16x32_bf16 v[120:123], a[52:55], a[124:127], v[120:123]
    ds_read_b128 a[124:127], v9 offset:19456
    v_add_f32 v19, v19, v58
    s_waitcnt lgkmcnt(11)
    v_mfma_f32_16x16x32_bf16 v[112:115], a[8:11], a[128:131], v[112:115]
    v_fma_f32 v72, v72, s42, -v16
    v_add_f32 v18, v18, v59
    v_mfma_f32_16x16x32_bf16 v[116:119], a[32:35], a[128:131], v[116:119]
    v_exp_f32 v72, v72
    v_mfma_f32_16x16x32_bf16 v[120:123], a[56:59], a[128:131], v[120:123]
    ds_read_b128 a[128:131], v9 offset:20480
    v_fma_f32 v73, v73, s42, -v16
    s_waitcnt lgkmcnt(11)
    v_mfma_f32_16x16x32_bf16 v[112:115], a[12:15], a[132:135], v[112:115]
    v_exp_f32 v73, v73
    v_mfma_f32_16x16x32_bf16 v[116:119], a[36:39], a[132:135], v[116:119]
    v_add_f32 v19, v19, v72
    v_fma_f32 v74, v74, s42, -v16
    v_mfma_f32_16x16x32_bf16 v[120:123], a[60:63], a[132:135], v[120:123]
    ds_read_b128 a[132:135], v9 offset:21504
    v_add_f32 v18, v18, v73
    s_waitcnt lgkmcnt(11)
    v_mfma_f32_16x16x32_bf16 v[112:115], a[16:19], a[136:139], v[112:115]
    v_exp_f32 v74, v74
    v_mfma_f32_16x16x32_bf16 v[116:119], a[40:43], a[136:139], v[116:119]
    v_fma_f32 v75, v75, s42, -v16
    v_add_f32 v19, v19, v74
    v_mfma_f32_16x16x32_bf16 v[120:123], a[64:67], a[136:139], v[120:123]
    ds_read_b128 a[136:139], v9 offset:22528
    v_fma_f32 v88, v88, s42, -v16
    s_waitcnt lgkmcnt(11)
    v_mfma_f32_16x16x32_bf16 v[112:115], a[20:23], a[140:143], v[112:115]
    v_exp_f32 v75, v75
    v_mfma_f32_16x16x32_bf16 v[116:119], a[44:47], a[140:143], v[116:119]
    v_exp_f32 v88, v88
    v_mfma_f32_16x16x32_bf16 v[120:123], a[68:71], a[140:143], v[120:123]
    ds_read_b128 a[140:143], v9 offset:23552
    v_add_f32 v18, v18, v75
    s_waitcnt lgkmcnt(11)
    v_mfma_f32_16x16x32_bf16 v[96:99], a[0:3], a[96:99], 0
    v_add_f32 v19, v19, v88
    v_cvt_pk_bf16_f32 v136, v112, v113
    v_mfma_f32_16x16x32_bf16 v[100:103], a[24:27], a[96:99], 0
    v_cvt_pk_bf16_f32 v137, v114, v115
    v_cvt_pk_bf16_f32 v138, v116, v117
    v_mfma_f32_16x16x32_bf16 v[104:107], a[48:51], a[96:99], 0
    v_cvt_pk_bf16_f32 v139, v118, v119
    v_cvt_pk_bf16_f32 v140, v120, v121
    s_waitcnt lgkmcnt(10)
    v_mfma_f32_16x16x32_bf16 v[96:99], a[4:7], a[100:103], v[96:99]
    v_cvt_pk_bf16_f32 v141, v122, v123
    v_add_f32 v18, v18, v19
    v_mfma_f32_16x16x32_bf16 v[100:103], a[28:31], a[100:103], v[100:103]
    v_mov_b32 v19, v18
    v_mfma_f32_16x16x32_bf16 v[104:107], a[52:55], a[100:103], v[104:107]
    s_waitcnt lgkmcnt(9)
    v_mfma_f32_16x16x32_bf16 v[96:99], a[8:11], a[104:107], v[96:99]
    v_permlane32_swap_b32 v18, v19
    v_mfma_f32_16x16x32_bf16 v[100:103], a[32:35], a[104:107], v[100:103]
    v_add_f32 v18, v18, v19
    v_mfma_f32_16x16x32_bf16 v[104:107], a[56:59], a[104:107], v[104:107]
    v_mov_b32 v19, v18
    s_waitcnt lgkmcnt(8)
    v_mfma_f32_16x16x32_bf16 v[96:99], a[12:15], a[108:111], v[96:99]
    v_mfma_f32_16x16x32_bf16 v[100:103], a[36:39], a[108:111], v[100:103]
    v_permlane16_swap_b32 v18, v19
    v_mfma_f32_16x16x32_bf16 v[104:107], a[60:63], a[108:111], v[104:107]
    v_add_f32 v18, v18, v19
    s_waitcnt lgkmcnt(7)
    v_mfma_f32_16x16x32_bf16 v[96:99], a[16:19], a[112:115], v[96:99]
    v_rcp_f32 v18, v18
    v_mfma_f32_16x16x32_bf16 v[100:103], a[40:43], a[112:115], v[100:103]
    v_mul_f32 v40, v40, v18
    v_mul_f32 v41, v41, v18
    v_mfma_f32_16x16x32_bf16 v[104:107], a[64:67], a[112:115], v[104:107]
    v_cvt_pk_bf16_f32 v176, v40, v41
    v_mul_f32 v42, v42, v18
    s_waitcnt lgkmcnt(6)
    v_mfma_f32_16x16x32_bf16 v[96:99], a[20:23], a[116:119], v[96:99]
    v_mul_f32 v43, v43, v18
    v_mul_f32 v56, v56, v18
    v_mfma_f32_16x16x32_bf16 v[100:103], a[44:47], a[116:119], v[100:103]
    v_cvt_pk_bf16_f32 v177, v42, v43
    v_mul_f32 v57, v57, v18
    v_mfma_f32_16x16x32_bf16 v[104:107], a[68:71], a[116:119], v[104:107]
    v_cvt_pk_bf16_f32 v178, v56, v57
    v_mul_f32 v58, v58, v18
    v_mfma_f32_16x16x32_bf16 v[32:35], v[128:131], v[160:163], 0
    v_cvt_pk_bf16_f32 v144, v96, v97
    v_cvt_pk_bf16_f32 v145, v98, v99
    v_mfma_f32_16x16x32_bf16 v[32:35], v[132:135], v[164:167], v[32:35]
    v_cvt_pk_bf16_f32 v146, v100, v101
    v_cvt_pk_bf16_f32 v147, v102, v103
    v_mfma_f32_16x16x32_bf16 v[48:51], v[136:139], v[160:163], 0
    v_cvt_pk_bf16_f32 v148, v104, v105
    v_cvt_pk_bf16_f32 v149, v106, v107
    v_mfma_f32_16x16x32_bf16 v[48:51], v[140:143], v[164:167], v[48:51]
    v_mul_f32 v59, v59, v18
    v_mul_f32 v72, v72, v18
    v_mfma_f32_16x16x32_bf16 v[44:47], v[128:131], v[184:187], 0
    v_cvt_pk_bf16_f32 v32, v32, v33
    v_cvt_pk_bf16_f32 v33, v34, v35
    v_mfma_f32_16x16x32_bf16 v[44:47], v[132:135], v[188:191], v[44:47]
    v_cvt_pk_bf16_f32 v179, v58, v59
    v_mul_f32 v73, v73, v18
    v_mfma_f32_16x16x32_bf16 v[60:63], v[136:139], v[184:187], 0
    v_cvt_pk_bf16_f32 v34, v48, v49
    v_cvt_pk_bf16_f32 v35, v50, v51
    v_mfma_f32_16x16x32_bf16 v[60:63], v[140:143], v[188:191], v[60:63]
    buffer_store_dwordx4 v[32:35], v2, s[24:27], 0 offen offset:256 sc1 nt
    v_cvt_pk_bf16_f32 v180, v72, v73
    v_mfma_f32_16x16x32_bf16 v[36:39], v[128:131], v[168:171], 0
    v_cvt_pk_bf16_f32 v44, v44, v45
    v_cvt_pk_bf16_f32 v45, v46, v47
    v_mfma_f32_16x16x32_bf16 v[36:39], v[132:135], v[172:175], v[36:39]
    v_mul_f32 v74, v74, v18
    v_mul_f32 v75, v75, v18
    v_mfma_f32_16x16x32_bf16 v[52:55], v[136:139], v[168:171], 0
    v_cvt_pk_bf16_f32 v46, v60, v61
    v_cvt_pk_bf16_f32 v47, v62, v63
    v_mfma_f32_16x16x32_bf16 v[52:55], v[140:143], v[172:175], v[52:55]
    buffer_store_dwordx4 v[44:47], v6, s[24:27], 0 offen offset:256 sc1 nt
    v_cvt_pk_bf16_f32 v181, v74, v75
    v_mfma_f32_16x16x32_bf16 v[40:43], v[192:195], v[176:179], 0
    v_cvt_pk_bf16_f32 v36, v36, v37
    v_cvt_pk_bf16_f32 v37, v38, v39
    v_mul_f32 v88, v88, v18
    v_mov_b32 v183, 0
    v_cvt_pk_bf16_f32 v182, v88, 0
    v_cvt_pk_bf16_f32 v38, v52, v53
    v_cvt_pk_bf16_f32 v39, v54, v55
    v_mfma_f32_16x16x32_bf16 v[40:43], v[196:199], v[180:183], v[40:43]
    buffer_store_dwordx4 v[36:39], v3, s[24:27], 0 offen offset:256 sc1 nt
    v_mfma_f32_16x16x32_bf16 v[56:59], v[200:203], v[176:179], 0
    v_mfma_f32_16x16x32_bf16 v[56:59], v[204:207], v[180:183], v[56:59]
    v_mfma_f32_16x16x32_bf16 v[72:75], v[208:211], v[176:179], 0
    v_mfma_f32_16x16x32_bf16 v[72:75], v[212:215], v[180:183], v[72:75]
    v_mfma_f32_16x16x32_bf16 v[88:91], v[216:219], v[176:179], 0
    v_mfma_f32_16x16x32_bf16 v[88:91], v[220:223], v[180:183], v[88:91]
    s_waitcnt lgkmcnt(5)
    v_mfma_f32_16x16x32_bf16 v[112:115], a[0:3], a[120:123], 0
    v_cvt_pk_bf16_f32 v40, v40, v41
    v_cvt_pk_bf16_f32 v41, v42, v43
    v_mfma_f32_16x16x32_bf16 v[116:119], a[24:27], a[120:123], 0
    v_cvt_pk_bf16_f32 v42, v56, v57
    v_cvt_pk_bf16_f32 v43, v58, v59
    v_mfma_f32_16x16x32_bf16 v[120:123], a[48:51], a[120:123], 0
    buffer_store_dwordx4 v[40:43], v4, s[24:27], 0 offen offset:0 sc1 nt
    v_cvt_pk_bf16_f32 v72, v72, v73
    s_waitcnt lgkmcnt(4)
    v_mfma_f32_16x16x32_bf16 v[112:115], a[4:7], a[124:127], v[112:115]
    v_cvt_pk_bf16_f32 v73, v74, v75
    v_cvt_pk_bf16_f32 v74, v88, v89
    v_mfma_f32_16x16x32_bf16 v[116:119], a[28:31], a[124:127], v[116:119]
    v_cvt_pk_bf16_f32 v75, v90, v91
    v_mfma_f32_16x16x32_bf16 v[120:123], a[52:55], a[124:127], v[120:123]
    buffer_store_dwordx4 v[72:75], v4, s[24:27], 0 offen offset:64 sc1 nt
    s_waitcnt lgkmcnt(3)
    v_mfma_f32_16x16x32_bf16 v[112:115], a[8:11], a[128:131], v[112:115]
    v_mfma_f32_16x16x32_bf16 v[116:119], a[32:35], a[128:131], v[116:119]
    v_mfma_f32_16x16x32_bf16 v[120:123], a[56:59], a[128:131], v[120:123]
    s_waitcnt lgkmcnt(2)
    v_mfma_f32_16x16x32_bf16 v[112:115], a[12:15], a[132:135], v[112:115]
    v_mfma_f32_16x16x32_bf16 v[116:119], a[36:39], a[132:135], v[116:119]
    v_mfma_f32_16x16x32_bf16 v[120:123], a[60:63], a[132:135], v[120:123]
    s_waitcnt lgkmcnt(1)
    v_mfma_f32_16x16x32_bf16 v[112:115], a[16:19], a[136:139], v[112:115]
    v_mfma_f32_16x16x32_bf16 v[116:119], a[40:43], a[136:139], v[116:119]
    v_mfma_f32_16x16x32_bf16 v[120:123], a[64:67], a[136:139], v[120:123]
    s_waitcnt lgkmcnt(0)
    v_mfma_f32_16x16x32_bf16 v[112:115], a[20:23], a[140:143], v[112:115]
    v_mfma_f32_16x16x32_bf16 v[116:119], a[44:47], a[140:143], v[116:119]
    v_mfma_f32_16x16x32_bf16 v[120:123], a[68:71], a[140:143], v[120:123]
    v_mfma_f32_16x16x32_bf16 v[40:43], v[224:227], v[176:179], 0
    v_mfma_f32_16x16x32_bf16 v[40:43], v[228:231], v[180:183], v[40:43]
    v_mfma_f32_16x16x32_bf16 v[56:59], v[232:235], v[176:179], 0
    v_mfma_f32_16x16x32_bf16 v[56:59], v[236:239], v[180:183], v[56:59]
    v_mfma_f32_16x16x32_bf16 v[72:75], v[240:243], v[176:179], 0
    v_mfma_f32_16x16x32_bf16 v[72:75], v[244:247], v[180:183], v[72:75]
    v_cvt_pk_bf16_f32 v152, v112, v113
    v_cvt_pk_bf16_f32 v153, v114, v115
    v_mfma_f32_16x16x32_bf16 v[88:91], v[248:251], v[176:179], 0
    v_cvt_pk_bf16_f32 v154, v116, v117
    v_cvt_pk_bf16_f32 v155, v118, v119
    v_mfma_f32_16x16x32_bf16 v[88:91], v[252:255], v[180:183], v[88:91]
    v_cvt_pk_bf16_f32 v156, v120, v121
    v_cvt_pk_bf16_f32 v157, v122, v123
    v_mfma_f32_16x16x32_bf16 v[64:67], v[144:147], v[160:163], 0
    v_cvt_pk_bf16_f32 v40, v40, v41
    v_cvt_pk_bf16_f32 v41, v42, v43
    v_mfma_f32_16x16x32_bf16 v[64:67], v[148:151], v[164:167], v[64:67]
    v_cvt_pk_bf16_f32 v42, v56, v57
    v_cvt_pk_bf16_f32 v43, v58, v59
    v_mfma_f32_16x16x32_bf16 v[80:83], v[152:155], v[160:163], 0
    buffer_store_dwordx4 v[40:43], v4, s[24:27], 0 offen offset:128 sc1 nt
    v_cvt_pk_bf16_f32 v72, v72, v73
    v_mfma_f32_16x16x32_bf16 v[80:83], v[156:159], v[164:167], v[80:83]
    v_cvt_pk_bf16_f32 v73, v74, v75
    v_cvt_pk_bf16_f32 v74, v88, v89
    v_mfma_f32_16x16x32_bf16 v[76:79], v[144:147], v[184:187], 0
    v_cvt_pk_bf16_f32 v75, v90, v91
    v_cvt_pk_bf16_f32 v64, v64, v65
    v_mfma_f32_16x16x32_bf16 v[76:79], v[148:151], v[188:191], v[76:79]
    buffer_store_dwordx4 v[72:75], v4, s[24:27], 0 offen offset:192 sc1 nt
    v_cvt_pk_bf16_f32 v65, v66, v67
    v_mfma_f32_16x16x32_bf16 v[92:95], v[152:155], v[184:187], 0
    v_cvt_pk_bf16_f32 v66, v80, v81
    v_cvt_pk_bf16_f32 v67, v82, v83
    v_mfma_f32_16x16x32_bf16 v[92:95], v[156:159], v[188:191], v[92:95]
    buffer_store_dwordx4 v[64:67], v2, s[24:27], 0 offen offset:320 sc1 nt
    v_mfma_f32_16x16x32_bf16 v[68:71], v[144:147], v[168:171], 0
    v_cvt_pk_bf16_f32 v76, v76, v77
    v_cvt_pk_bf16_f32 v77, v78, v79
    v_mfma_f32_16x16x32_bf16 v[68:71], v[148:151], v[172:175], v[68:71]
    v_mfma_f32_16x16x32_bf16 v[84:87], v[152:155], v[168:171], 0
    v_mfma_f32_16x16x32_bf16 v[84:87], v[156:159], v[172:175], v[84:87]
    v_mfma_f32_16x16x32_bf16 v[40:43], v[128:131], v[176:179], 0
    v_cvt_pk_bf16_f32 v78, v92, v93
    v_cvt_pk_bf16_f32 v79, v94, v95
    v_mfma_f32_16x16x32_bf16 v[40:43], v[132:135], v[180:183], v[40:43]
    buffer_store_dwordx4 v[76:79], v6, s[24:27], 0 offen offset:320 sc1 nt
    v_mfma_f32_16x16x32_bf16 v[56:59], v[136:139], v[176:179], 0
    v_cvt_pk_bf16_f32 v68, v68, v69
    v_cvt_pk_bf16_f32 v69, v70, v71
    v_mfma_f32_16x16x32_bf16 v[56:59], v[140:143], v[180:183], v[56:59]
    v_cvt_pk_bf16_f32 v70, v84, v85
    v_cvt_pk_bf16_f32 v71, v86, v87
    v_mfma_f32_16x16x32_bf16 v[72:75], v[144:147], v[176:179], 0
    buffer_store_dwordx4 v[68:71], v3, s[24:27], 0 offen offset:320 sc1 nt
    v_cvt_pk_bf16_f32 v40, v40, v41
    v_mfma_f32_16x16x32_bf16 v[72:75], v[148:151], v[180:183], v[72:75]
    v_cvt_pk_bf16_f32 v41, v42, v43
    v_mfma_f32_16x16x32_bf16 v[88:91], v[152:155], v[176:179], 0
    v_cvt_pk_bf16_f32 v42, v56, v57
    v_cvt_pk_bf16_f32 v43, v58, v59
    v_mfma_f32_16x16x32_bf16 v[88:91], v[156:159], v[180:183], v[88:91]
    buffer_store_dwordx4 v[40:43], v4, s[24:27], 0 offen offset:256 sc1 nt
    s_nop 1
    v_cvt_pk_bf16_f32 v72, v72, v73
    v_cvt_pk_bf16_f32 v73, v74, v75
    s_nop 2
    v_cvt_pk_bf16_f32 v74, v88, v89
    v_cvt_pk_bf16_f32 v75, v90, v91
    buffer_store_dwordx4 v[72:75], v4, s[24:27], 0 offen offset:320 sc1 nt
L_end:
    s_endpgm
L_slowN:
    s_movk_i32 s73, 400
L_pollN:
    s_sleep 4
    buffer_load_dword v23, v22, s[36:39], 0 offen offset:132 sc1
    s_waitcnt vmcnt(0)
    v_cmp_ne_u32 vcc, 16843009, v23
    s_nop 0
    s_cmp_eq_u64 vcc, 0
    s_cbranch_scc1 L_okN
    s_sub_u32 s73, s73, 1
    s_cbranch_scc0 L_pollN
    s_mov_b32 s74, 0
L_fb:
    s_mul_i32 s54, s74, 43
    s_lshr_b32 s54, s54, 8
    s_mul_i32 s52, s54, 6
    s_sub_u32 s55, s74, s52
    v_and_b32 v16, 15, v1
    v_lshrrev_b32 v17, 4, v1
    v_lshrrev_b32 v20, 2, v16
    v_and_b32 v19, 3, v16
    v_lshl_add_u32 v18, v20, 3, v19
    v_mul_u32_u24 v18, 1152, v18
    v_lshl_add_u32 v18, v17, 4, v18
    s_mul_i32 s52, s55, 36864
    v_add_u32 v18, s52, v18
    v_lshl_add_u32 v21, v17, 3, v20
    v_lshlrev_b32 v21, 6, v21
    v_lshl_add_u32 v21, v19, 4, v21
    v_add_u32 v21, 0, v21
    v_lshrrev_b32 v20, 2, v1
    v_mul_u32_u24 v20, 384, v20
    v_and_b32 v19, 3, v1
    v_lshl_add_u32 v19, v19, 4, v20
    s_lshl_b32 s52, s54, 6
    v_add_u32 v19, s52, v19
    s_movk_i32 s53, 4608
    s_mov_b32 s52, 0
    s_mov_b32 m0, 0
    s_nop 0
    buffer_load_dwordx4 v19, s[32:35], s52 offen lds
    s_mov_b32 s52, 6144
    s_mov_b32 m0, 1024
    s_nop 0
    buffer_load_dwordx4 v19, s[32:35], s52 offen lds
    s_mov_b32 s52, 12288
    s_mov_b32 m0, 2048
    s_nop 0
    buffer_load_dwordx4 v19, s[32:35], s52 offen lds
    s_mov_b32 s52, 18432
    s_mov_b32 m0, 3072
    s_nop 0
    buffer_load_dwordx4 v19, s[32:35], s52 offen lds
    s_mov_b32 s52, 24576
    s_mov_b32 m0, 4096
    s_nop 0
    buffer_load_dwordx4 v19, s[32:35], s52 offen lds
    s_mov_b32 s52, 30720
    s_mov_b32 m0, 5120
    s_nop 0
    buffer_load_dwordx4 v19, s[32:35], s52 offen lds
    s_mov_b32 s52, 36864
    s_mov_b32 m0, 6144
    s_nop 0
    buffer_load_dwordx4 v19, s[32:35], s52 offen lds
    s_mov_b32 s52, 43008
    s_mov_b32 m0, 7168
    s_nop 0
    buffer_load_dwordx4 v19, s[32:35], s52 offen lds
    s_mov_b32 s52, 49152
    s_mov_b32 m0, 8192
    s_nop 0
    buffer_load_dwordx4 v19, s[32:35], s52 offen lds
    s_mov_b32 s52, 55296
    s_mov_b32 m0, 9216
    s_nop 0
    buffer_load_dwordx4 v19, s[32:35], s52 offen lds
    s_mov_b32 s52, 61440
    s_mov_b32 m0, 43008
    s_nop 0
    buffer_load_dwordx4 v19, s[32:35], s52 offen lds
    s_mov_b32 s52, 67584
    s_mov_b32 m0, 44032
    s_nop 0
    buffer_load_dwordx4 v19, s[32:35], s52 offen lds
    buffer_load_dwordx4 a[144:147], v18, s[20:23], 0 offen offset:768
    buffer_load_dwordx4 a[168:171], v18, s[20:23], s53 offen offset:768
    buffer_load_dwordx4 a[148:151], v18, s[20:23], 0 offen offset:832
    buffer_load_dwordx4 a[172:175], v18, s[20:23], s53 offen offset:832
    buffer_load_dwordx4 a[152:155], v18, s[20:23], 0 offen offset:896
    buffer_load_dwordx4 a[176:179], v18, s[20:23], s53 offen offset:896
    buffer_load_dwordx4 a[156:159], v18, s[20:23], 0 offen offset:960
    buffer_load_dwordx4 a[180:183], v18, s[20:23], s53 offen offset:960
    buffer_load_dwordx4 a[160:163], v18, s[20:23], 0 offen offset:1024
    buffer_load_dwordx4 a[184:187], v18, s[20:23], s53 offen offset:1024
    buffer_load_dwordx4 a[164:167], v18, s[20:23], 0 offen offset:1088
    buffer_load_dwordx4 a[188:191], v18, s[20:23], s53 offen offset:1088
    s_waitcnt vmcnt(0)
    ds_read_b64_tr_b16 v[176:177], v21 offset:0
    ds_read_b64_tr_b16 v[178:179], v21 offset:256
    ds_read_b64_tr_b16 v[200:201], v21 offset:8
    ds_read_b64_tr_b16 v[202:203], v21 offset:264
    ds_read_b64_tr_b16 v[180:181], v21 offset:2048
    ds_read_b64_tr_b16 v[182:183], v21 offset:2304
    ds_read_b64_tr_b16 v[204:205], v21 offset:2056
    ds_read_b64_tr_b16 v[206:207], v21 offset:2312
    ds_read_b64_tr_b16 v[184:185], v21 offset:4096
    ds_read_b64_tr_b16 v[186:187], v21 offset:4352
    ds_read_b64_tr_b16 v[208:209], v21 offset:4104
    ds_read_b64_tr_b16 v[210:211], v21 offset:4360
    ds_read_b64_tr_b16 v[188:189], v21 offset:6144
    ds_read_b64_tr_b16 v[190:191], v21 offset:6400
    ds_read_b64_tr_b16 v[212:213], v21 offset:6152
    ds_read_b64_tr_b16 v[214:215], v21 offset:6408
    ds_read_b64_tr_b16 v[192:193], v21 offset:8192
    ds_read_b64_tr_b16 v[194:195], v21 offset:8448
    ds_read_b64_tr_b16 v[216:217], v21 offset:8200
    ds_read_b64_tr_b16 v[218:219], v21 offset:8456
    ds_read_b64_tr_b16 v[196:197], v21 offset:43008
    ds_read_b64_tr_b16 v[198:199], v21 offset:43264
    ds_read_b64_tr_b16 v[220:221], v21 offset:43016
    ds_read_b64_tr_b16 v[222:223], v21 offset:43272
    s_waitcnt lgkmcnt(15)
    v_mfma_f32_16x16x32_bf16 v[224:227], a[144:147], v[176:179], 0
    v_mfma_f32_16x16x32_bf16 v[228:231], a[168:171], v[176:179], 0
    v_mfma_f32_16x16x32_bf16 v[232:235], a[144:147], v[200:203], 0
    v_mfma_f32_16x16x32_bf16 v[236:239], a[168:171], v[200:203], 0
    v_mfma_f32_16x16x32_bf16 v[224:227], a[148:151], v[180:183], v[224:227]
    v_mfma_f32_16x16x32_bf16 v[228:231], a[172:175], v[180:183], v[228:231]
    v_mfma_f32_16x16x32_bf16 v[232:235], a[148:151], v[204:207], v[232:235]
    v_mfma_f32_16x16x32_bf16 v[236:239], a[172:175], v[204:207], v[236:239]
    s_waitcnt lgkmcnt(14)
    v_mfma_f32_16x16x32_bf16 v[224:227], a[152:155], v[184:187], v[224:227]
    v_mfma_f32_16x16x32_bf16 v[228:231], a[176:179], v[184:187], v[228:231]
    s_waitcnt lgkmcnt(12)
    v_mfma_f32_16x16x32_bf16 v[232:235], a[152:155], v[208:211], v[232:235]
    v_mfma_f32_16x16x32_bf16 v[236:239], a[176:179], v[208:211], v[236:239]
    s_waitcnt lgkmcnt(10)
    v_mfma_f32_16x16x32_bf16 v[224:227], a[156:159], v[188:191], v[224:227]
    v_mfma_f32_16x16x32_bf16 v[228:231], a[180:183], v[188:191], v[228:231]
    s_waitcnt lgkmcnt(8)
    v_mfma_f32_16x16x32_bf16 v[232:235], a[156:159], v[212:215], v[232:235]
    v_mfma_f32_16x16x32_bf16 v[236:239], a[180:183], v[212:215], v[236:239]
    s_waitcnt lgkmcnt(6)
    v_mfma_f32_16x16x32_bf16 v[224:227], a[160:163], v[192:195], v[224:227]
    v_mfma_f32_16x16x32_bf16 v[228:231], a[184:187], v[192:195], v[228:231]
    s_waitcnt lgkmcnt(4)
    v_mfma_f32_16x16x32_bf16 v[232:235], a[160:163], v[216:219], v[232:235]
    v_mfma_f32_16x16x32_bf16 v[236:239], a[184:187], v[216:219], v[236:239]
    s_waitcnt lgkmcnt(2)
    v_mfma_f32_16x16x32_bf16 v[224:227], a[164:167], v[196:199], v[224:227]
    v_mfma_f32_16x16x32_bf16 v[228:231], a[188:191], v[196:199], v[228:231]
    s_waitcnt lgkmcnt(0)
    v_mfma_f32_16x16x32_bf16 v[232:235], a[164:167], v[220:223], v[232:235]
    v_mfma_f32_16x16x32_bf16 v[236:239], a[188:191], v[220:223], v[236:239]
    s_mul_i32 s52, s54, 12288
    s_lshl_b32 s53, s55, 10
    s_add_u32 s52, s52, s53
    s_add_u32 s53, s52, 6144
    v_cvt_pk_bf16_f32 v240, v224, v225
    v_cvt_pk_bf16_f32 v241, v226, v227
    v_cvt_pk_bf16_f32 v242, v228, v229
    v_cvt_pk_bf16_f32 v243, v230, v231
    buffer_store_dwordx4 v[240:243], v7, s[28:31], s52 offen offset:0 sc1
    v_cvt_pk_bf16_f32 v244, v232, v233
    v_cvt_pk_bf16_f32 v245, v234, v235
    v_cvt_pk_bf16_f32 v246, v236, v237
    v_cvt_pk_bf16_f32 v247, v238, v239
    buffer_store_dwordx4 v[244:247], v7, s[28:31], s53 offen offset:0 sc1
    s_nop 1
    s_add_u32 s74, s74, 1
    s_cmp_lt_u32 s74, 36
    s_cbranch_scc1 L_fb
    s_waitcnt vmcnt(0)
    s_branch L_okN
L_slowM:
    s_movk_i32 s73, 400
L_pollM:
    s_sleep 2
    buffer_load_dword v23, off, s[36:39], 0 offset:128 sc1
    s_waitcnt vmcnt(0)
    v_cmp_ne_u32 vcc, 16843009, v23
    s_nop 0
    s_cmp_eq_u64 vcc, 0
    s_cbranch_scc1 L_okM
    s_sub_u32 s73, s73, 1
    s_cbranch_scc0 L_pollM
    s_mov_b32 s74, 0
L_fbM:
    s_mul_i32 s54, s74, 43
    s_lshr_b32 s54, s54, 8
    s_mul_i32 s52, s54, 6
    s_sub_u32 s55, s74, s52
    v_and_b32 v16, 15, v1
    v_lshrrev_b32 v17, 4, v1
    v_lshrrev_b32 v20, 2, v16
    v_and_b32 v19, 3, v16
    v_lshl_add_u32 v18, v20, 3, v19
    v_mul_u32_u24 v18, 1152, v18
    v_lshl_add_u32 v18, v17, 4, v18
    s_mul_i32 s52, s54, 36864
    v_add_u32 v19, s52, v18
    s_mul_i32 s52, s55, 36864
    v_add_u32 v18, s52, v18
    s_movk_i32 s53, 4608
    buffer_load_dwordx4 a[144:147], v18, s[20:23], 0 offen offset:0
    buffer_load_dwordx4 v[176:179], v19, s[20:23], 0 offen offset:384
    buffer_load_dwordx4 a[168:171], v18, s[20:23], s53 offen offset:0
    buffer_load_dwordx4 v[200:203], v19, s[20:23], s53 offen offset:384
    buffer_load_dwordx4 a[148:151], v18, s[20:23], 0 offen offset:64
    buffer_load_dwordx4 v[180:183], v19, s[20:23], 0 offen offset:448
    buffer_load_dwordx4 a[172:175], v18, s[20:23], s53 offen offset:64
    buffer_load_dwordx4 v[204:207], v19, s[20:23], s53 offen offset:448
    buffer_load_dwordx4 a[152:155], v18, s[20:23], 0 offen offset:128
    buffer_load_dwordx4 v[184:187], v19, s[20:23], 0 offen offset:512
    buffer_load_dwordx4 a[176:179], v18, s[20:23], s53 offen offset:128
    buffer_load_dwordx4 v[208:211], v19, s[20:23], s53 offen offset:512
    buffer_load_dwordx4 a[156:159], v18, s[20:23], 0 offen offset:192
    buffer_load_dwordx4 v[188:191], v19, s[20:23], 0 offen offset:576
    buffer_load_dwordx4 a[180:183], v18, s[20:23], s53 offen offset:192
    buffer_load_dwordx4 v[212:215], v19, s[20:23], s53 offen offset:576
    buffer_load_dwordx4 a[160:163], v18, s[20:23], 0 offen offset:256
    buffer_load_dwordx4 v[192:195], v19, s[20:23], 0 offen offset:640
    buffer_load_dwordx4 a[184:187], v18, s[20:23], s53 offen offset:256
    buffer_load_dwordx4 v[216:219], v19, s[20:23], s53 offen offset:640
    buffer_load_dwordx4 a[164:167], v18, s[20:23], 0 offen offset:320
    buffer_load_dwordx4 v[196:199], v19, s[20:23], 0 offen offset:704
    buffer_load_dwordx4 a[188:191], v18, s[20:23], s53 offen offset:320
    buffer_load_dwordx4 v[220:223], v19, s[20:23], s53 offen offset:704
    s_waitcnt vmcnt(0)
    v_mfma_f32_16x16x32_bf16 v[224:227], a[144:147], v[176:179], 0
    v_mfma_f32_16x16x32_bf16 v[228:231], a[168:171], v[176:179], 0
    v_mfma_f32_16x16x32_bf16 v[232:235], a[144:147], v[200:203], 0
    v_mfma_f32_16x16x32_bf16 v[236:239], a[168:171], v[200:203], 0
    v_mfma_f32_16x16x32_bf16 v[224:227], a[148:151], v[180:183], v[224:227]
    v_mfma_f32_16x16x32_bf16 v[228:231], a[172:175], v[180:183], v[228:231]
    v_mfma_f32_16x16x32_bf16 v[232:235], a[148:151], v[204:207], v[232:235]
    v_mfma_f32_16x16x32_bf16 v[236:239], a[172:175], v[204:207], v[236:239]
    v_mfma_f32_16x16x32_bf16 v[224:227], a[152:155], v[184:187], v[224:227]
    v_mfma_f32_16x16x32_bf16 v[228:231], a[176:179], v[184:187], v[228:231]
    v_mfma_f32_16x16x32_bf16 v[232:235], a[152:155], v[208:211], v[232:235]
    v_mfma_f32_16x16x32_bf16 v[236:239], a[176:179], v[208:211], v[236:239]
    v_mfma_f32_16x16x32_bf16 v[224:227], a[156:159], v[188:191], v[224:227]
    v_mfma_f32_16x16x32_bf16 v[228:231], a[180:183], v[188:191], v[228:231]
    v_mfma_f32_16x16x32_bf16 v[232:235], a[156:159], v[212:215], v[232:235]
    v_mfma_f32_16x16x32_bf16 v[236:239], a[180:183], v[212:215], v[236:239]
    v_mfma_f32_16x16x32_bf16 v[224:227], a[160:163], v[192:195], v[224:227]
    v_mfma_f32_16x16x32_bf16 v[228:231], a[184:187], v[192:195], v[228:231]
    v_mfma_f32_16x16x32_bf16 v[232:235], a[160:163], v[216:219], v[232:235]
    v_mfma_f32_16x16x32_bf16 v[236:239], a[184:187], v[216:219], v[236:239]
    v_mfma_f32_16x16x32_bf16 v[224:227], a[164:167], v[196:199], v[224:227]
    v_mfma_f32_16x16x32_bf16 v[228:231], a[188:191], v[196:199], v[228:231]
    v_mfma_f32_16x16x32_bf16 v[232:235], a[164:167], v[220:223], v[232:235]
    v_mfma_f32_16x16x32_bf16 v[236:239], a[188:191], v[220:223], v[236:239]
    s_mul_i32 s52, s54, 12288
    s_lshl_b32 s53, s55, 10
    s_add_u32 s52, s52, s53
    s_add_u32 s52, s52, 73728
    s_add_u32 s53, s52, 6144
    v_cvt_pk_bf16_f32 v240, v224, v225
    v_cvt_pk_bf16_f32 v241, v226, v227
    v_cvt_pk_bf16_f32 v242, v228, v229
    v_cvt_pk_bf16_f32 v243, v230, v231
    buffer_store_dwordx4 v[240:243], v7, s[28:31], s52 offen offset:0 sc1
    v_cvt_pk_bf16_f32 v244, v232, v233
    v_cvt_pk_bf16_f32 v245, v234, v235
    v_cvt_pk_bf16_f32 v246, v236, v237
    v_cvt_pk_bf16_f32 v247, v238, v239
    buffer_store_dwordx4 v[244:247], v7, s[28:31], s53 offen offset:0 sc1
    s_nop 1
    s_add_u32 s74, s74, 1
    s_cmp_lt_u32 s74, 36
    s_cbranch_scc1 L_fbM
    s_waitcnt vmcnt(0)
    s_branch L_okM
.p2align 6
L_cend:
.section .rodata,"a"
.p2align 6
.amdhsa_kernel standalone__swin_window_attn__vision_kernel
  .amdhsa_next_free_vgpr 448
  .amdhsa_next_free_sgpr 102
  .amdhsa_accum_offset 256
  .amdhsa_group_segment_fixed_size 0
  .amdhsa_kernarg_size 48
  .amdhsa_user_sgpr_count 2
  .amdhsa_user_sgpr_kernarg_segment_ptr 1
  .amdhsa_system_sgpr_workgroup_id_x 1
.end_amdhsa_kernel
```
